```python
import torch

def _softmax(x, axis=-1):
    return torch.softmax(x, dim=axis)
def _gelu(x):
    return torch.nn.functional.gelu(x, approximate="tanh")
def _silu(x):
    return torch.nn.functional.silu(x)
def _sigmoid(x):
    return torch.sigmoid(x)
def _layernorm(x, axis=-1, eps=1e-5):
    m = x.mean(dim=axis, keepdim=True)
    v = x.var(dim=axis, keepdim=True, unbiased=False)
    return (x - m) / torch.sqrt(v + eps)
def _scatter_add(tgt, idx, src, axis=0):
    return tgt.clone().index_add_(axis, idx, src)
def _segment_sum(src, seg, n):
    out = torch.zeros((n,) + src.shape[1:], dtype=src.dtype)
    return out.index_add_(0, seg, src)
def _pad(x, pw):
    flat = tuple(v for pair in reversed(pw) for v in pair)
    return torch.nn.functional.pad(x, flat)

kernel_name = 'standalone__global_local_windowed_global_tokens__prompt'

def setup_inputs():

    _w = (lambda a: (lambda t: t.to(torch.bfloat16) if t.is_floating_point() else t)(torch.as_tensor(a)))
    B, H, S, D = 1, 32, 2048, 192
    return {
        "q": _w((lambda *s: torch.randn(*s, dtype=torch.bfloat16) * 0.8)(B, H, S, D)),
        "k": _w((lambda *s: torch.randn(*s, dtype=torch.bfloat16) * 0.8)(B, H, S, D)),
        "v": _w((lambda *s: torch.randn(*s, dtype=torch.bfloat16) * 0.05)(B, H, S, D)),
        "window": 32,
        "n_global": 2,
    }

def reference(q, k, v, window, n_global):
    B, H, S, D = q.shape
    scale = D ** -0.5
    scores = torch.einsum("bhqd,bhkd->bhqk", q, k) * scale
    idx = torch.arange(S)
    dist = idx[:, None] - idx[None, :]
    local = (dist <= window) & (dist >= -window)
    is_global_q = (idx < n_global)[:, None]
    is_global_k = (idx < n_global)[None, :]
    mask = local | is_global_q | is_global_k
    scores = torch.where(mask[None, None], scores, -1e9)
    p = _softmax(scores, axis=-1)
    return torch.einsum("bhqk,bhkd->bhqd", p, v)
```

```asm
; @launch grid=(256,1,1) block=(448,1,1) lds=161920
.amdgcn_target "amdgcn-amd-amdhsa--gfx950"
.text
.globl standalone__global_local_windowed_global_tokens__prompt_kernel

.p2align 8
.type standalone__global_local_windowed_global_tokens__prompt_kernel,@function
standalone__global_local_windowed_global_tokens__prompt_kernel:
    s_load_dwordx2 s[8:9], s[0:1], 8
    s_load_dwordx2 s[12:13], s[0:1], 16
    s_load_dwordx2 s[4:5], s[0:1], 0
    s_load_dwordx2 s[16:17], s[0:1], 40
    s_load_dwordx2 s[24:25], s[0:1], 48
    s_load_dwordx2 s[20:21], s[0:1], 56
    s_cmp_ge_u32 s2, 256
    s_cbranch_scc1 L_end
    v_lshrrev_b32 v50, 6, v0
    v_and_b32 v0, 63, v0
    v_readfirstlane_b32 s98, v50
    s_and_b32 s35, s2, 7
    s_lshr_b32 s36, s2, 3
    s_lshr_b32 s37, s36, 3
    s_lshl_b32 s29, s35, 2
    s_add_u32 s29, s29, s37
    s_and_b32 s30, s36, 7
    s_and_b32 s31, s30, 1
    s_mul_i32 s34, s29, 786432
    s_mul_i32 s35, s30, 98304
    s_add_u32 s35, s35, s34
    s_movk_i32 s33, 6144
    s_cmp_eq_u32 s31, 1
    s_cselect_b32 s33, -6144, s33
    s_cselect_b32 s36, 92160, 0
    s_add_u32 s48, s35, s36
    v_lshlrev_b32 v51, 4, v0
    s_mov_b32 s46, 0x1000000
    s_mov_b32 s6, 25165824
    s_mov_b32 s7, 0x20000
    s_mov_b32 s10, 25165824
    s_mov_b32 s11, 0x20000
    s_mov_b32 s14, 25165824
    s_mov_b32 s15, 0x20000
    v_and_b32 v7, 31, v0
    v_lshlrev_b32 v7, 2, v7
    v_add_u32 v7, 161792, v7
    v_mov_b32 v5, 0
    ds_write_b32 v7, v5
    v_mul_u32_u24 v52, 2731, v0
    v_lshrrev_b32 v52, 12, v52
    v_and_b32 v52, 0x60, v52
    v_xor_b32 v1, v52, v51
    v_add_u32 v52, 64, v0
    v_mul_u32_u24 v52, 2731, v52
    v_lshrrev_b32 v52, 12, v52
    v_and_b32 v52, 0x60, v52
    v_xor_b32 v2, v52, v51
    v_add_u32 v52, 128, v0
    v_mul_u32_u24 v52, 2731, v52
    v_lshrrev_b32 v52, 12, v52
    v_and_b32 v52, 0x60, v52
    v_xor_b32 v3, v52, v51
    s_lshl_b32 s35, s33, 1
    s_add_u32 s37, s30, 1
    s_and_b32 s37, s37, 7
    s_cmp_lt_u32 s37, 2
    s_cselect_b32 s54, s35, 0
    s_add_u32 s54, s54, s48
    s_mov_b32 s56, 0
    v_mov_b32 v8, 0
    s_mov_b32 m0, 160768
    v_mov_b32 v6, 0
    v_mov_b32 v9, 161856
    s_waitcnt lgkmcnt(0)
    s_cmp_eq_u32 s98, 0
    s_cbranch_scc1 L_loader
    s_barrier
    s_branch L_cons
L_loader:
    buffer_load_dwordx4 v51, s[8:11], s34 offen lds
    s_mov_b32 m0, 159744
    s_nop 0
    buffer_load_dwordx4 v51, s[12:15], s34 offen lds
    s_mov_b32 m0, 110592
    s_add_u32 s93, s48, 3072
    buffer_load_dwordx4 v1, s[4:7], s48 offen offset:0 nt lds
    buffer_load_dwordx4 v2, s[4:7], s48 offen offset:1024 nt lds
    buffer_load_dwordx4 v3, s[4:7], s48 offen offset:2048 nt lds
    s_mov_b32 m0, 113664
    s_nop 0
    buffer_load_dwordx4 v1, s[4:7], s93 offen offset:0 nt lds
    buffer_load_dwordx4 v2, s[4:7], s93 offen offset:1024 nt lds
    buffer_load_dwordx4 v3, s[4:7], s93 offen offset:2048 nt lds
    s_mul_i32 s50, s33, -2
    s_add_u32 s50, s50, s54
    s_mov_b32 m0, 0
    s_add_u32 s93, s50, 3072
    buffer_load_dwordx4 v1, s[8:11], s50 offen offset:0 nt lds
    buffer_load_dwordx4 v2, s[8:11], s50 offen offset:1024 nt lds
    buffer_load_dwordx4 v3, s[8:11], s50 offen offset:2048 nt lds
    s_mov_b32 m0, 3072
    s_nop 0
    buffer_load_dwordx4 v1, s[8:11], s93 offen offset:0 nt lds
    buffer_load_dwordx4 v2, s[8:11], s93 offen offset:1024 nt lds
    buffer_load_dwordx4 v3, s[8:11], s93 offen offset:2048 nt lds
    s_mul_i32 s50, s33, -1
    s_add_u32 s50, s50, s54
    s_mov_b32 m0, 6144
    s_add_u32 s93, s50, 3072
    buffer_load_dwordx4 v1, s[8:11], s50 offen offset:0 nt lds
    buffer_load_dwordx4 v2, s[8:11], s50 offen offset:1024 nt lds
    buffer_load_dwordx4 v3, s[8:11], s50 offen offset:2048 nt lds
    s_mov_b32 m0, 9216
    s_nop 0
    buffer_load_dwordx4 v1, s[8:11], s93 offen offset:0 nt lds
    buffer_load_dwordx4 v2, s[8:11], s93 offen offset:1024 nt lds
    buffer_load_dwordx4 v3, s[8:11], s93 offen offset:2048 nt lds
    s_mov_b32 m0, 12288
    s_add_u32 s93, s48, 3072
    buffer_load_dwordx4 v1, s[8:11], s48 offen offset:0 nt lds
    buffer_load_dwordx4 v2, s[8:11], s48 offen offset:1024 nt lds
    buffer_load_dwordx4 v3, s[8:11], s48 offen offset:2048 nt lds
    s_mov_b32 m0, 15360
    s_nop 0
    buffer_load_dwordx4 v1, s[8:11], s93 offen offset:0 nt lds
    buffer_load_dwordx4 v2, s[8:11], s93 offen offset:1024 nt lds
    buffer_load_dwordx4 v3, s[8:11], s93 offen offset:2048 nt lds
    s_mul_i32 s50, s33, 1
    s_add_u32 s50, s50, s48
    s_mov_b32 m0, 18432
    s_add_u32 s93, s50, 3072
    buffer_load_dwordx4 v1, s[8:11], s50 offen offset:0 nt lds
    buffer_load_dwordx4 v2, s[8:11], s50 offen offset:1024 nt lds
    buffer_load_dwordx4 v3, s[8:11], s50 offen offset:2048 nt lds
    s_mov_b32 m0, 21504
    s_nop 0
    buffer_load_dwordx4 v1, s[8:11], s93 offen offset:0 nt lds
    buffer_load_dwordx4 v2, s[8:11], s93 offen offset:1024 nt lds
    buffer_load_dwordx4 v3, s[8:11], s93 offen offset:2048 nt lds
    s_waitcnt lgkmcnt(0)
    s_barrier
    s_mul_i32 s50, s33, 2
    s_add_u32 s50, s50, s48
    s_mov_b32 m0, 24576
    s_add_u32 s93, s50, 3072
    buffer_load_dwordx4 v1, s[8:11], s50 offen offset:0 nt lds
    buffer_load_dwordx4 v2, s[8:11], s50 offen offset:1024 nt lds
    buffer_load_dwordx4 v3, s[8:11], s50 offen offset:2048 nt lds
    s_mov_b32 m0, 27648
    s_nop 0
    buffer_load_dwordx4 v1, s[8:11], s93 offen offset:0 nt lds
    buffer_load_dwordx4 v2, s[8:11], s93 offen offset:1024 nt lds
    buffer_load_dwordx4 v3, s[8:11], s93 offen offset:2048 nt lds
    s_call_b64 s[40:41], F_wait
    s_mul_i32 s50, s33, 1
    s_add_u32 s50, s50, s48
    s_mov_b32 m0, 116736
    s_add_u32 s93, s50, 3072
    buffer_load_dwordx4 v1, s[4:7], s50 offen offset:0 nt lds
    buffer_load_dwordx4 v2, s[4:7], s50 offen offset:1024 nt lds
    buffer_load_dwordx4 v3, s[4:7], s50 offen offset:2048 nt lds
    s_call_b64 s[40:41], F_wait
    s_mov_b32 m0, 119808
    s_nop 0
    buffer_load_dwordx4 v1, s[4:7], s93 offen offset:0 nt lds
    buffer_load_dwordx4 v2, s[4:7], s93 offen offset:1024 nt lds
    buffer_load_dwordx4 v3, s[4:7], s93 offen offset:2048 nt lds
    s_call_b64 s[40:41], F_wait
    s_mul_i32 s50, s33, 3
    s_add_u32 s50, s50, s48
    s_mov_b32 m0, 30720
    s_add_u32 s93, s50, 3072
    buffer_load_dwordx4 v1, s[8:11], s50 offen offset:0 nt lds
    buffer_load_dwordx4 v2, s[8:11], s50 offen offset:1024 nt lds
    buffer_load_dwordx4 v3, s[8:11], s50 offen offset:2048 nt lds
    s_call_b64 s[40:41], F_wait
    s_mov_b32 m0, 33792
    s_nop 0
    buffer_load_dwordx4 v1, s[8:11], s93 offen offset:0 nt lds
    buffer_load_dwordx4 v2, s[8:11], s93 offen offset:1024 nt lds
    buffer_load_dwordx4 v3, s[8:11], s93 offen offset:2048 nt lds
    s_call_b64 s[40:41], F_wait
    s_mul_i32 s50, s33, -2
    s_add_u32 s50, s50, s54
    s_mov_b32 m0, 55296
    s_add_u32 s93, s50, 3072
    buffer_load_dwordx4 v1, s[12:15], s50 offen offset:0 nt lds
    buffer_load_dwordx4 v2, s[12:15], s50 offen offset:1024 nt lds
    buffer_load_dwordx4 v3, s[12:15], s50 offen offset:2048 nt lds
    s_call_b64 s[40:41], F_wait
    s_mov_b32 m0, 58368
    s_nop 0
    buffer_load_dwordx4 v1, s[12:15], s93 offen offset:0 nt lds
    buffer_load_dwordx4 v2, s[12:15], s93 offen offset:1024 nt lds
    buffer_load_dwordx4 v3, s[12:15], s93 offen offset:2048 nt lds
    s_call_b64 s[40:41], F_wait
    s_mul_i32 s50, s33, -1
    s_add_u32 s50, s50, s54
    s_mov_b32 m0, 61440
    s_add_u32 s93, s50, 3072
    buffer_load_dwordx4 v1, s[12:15], s50 offen offset:0 nt lds
    buffer_load_dwordx4 v2, s[12:15], s50 offen offset:1024 nt lds
    buffer_load_dwordx4 v3, s[12:15], s50 offen offset:2048 nt lds
    s_call_b64 s[40:41], F_wait
    s_mov_b32 m0, 64512
    s_nop 0
    buffer_load_dwordx4 v1, s[12:15], s93 offen offset:0 nt lds
    buffer_load_dwordx4 v2, s[12:15], s93 offen offset:1024 nt lds
    buffer_load_dwordx4 v3, s[12:15], s93 offen offset:2048 nt lds
    s_call_b64 s[40:41], F_wait
    s_mov_b32 m0, 67584
    s_add_u32 s93, s48, 3072
    buffer_load_dwordx4 v1, s[12:15], s48 offen offset:0 nt lds
    buffer_load_dwordx4 v2, s[12:15], s48 offen offset:1024 nt lds
    buffer_load_dwordx4 v3, s[12:15], s48 offen offset:2048 nt lds
    s_call_b64 s[40:41], F_wait
    s_mov_b32 m0, 70656
    s_nop 0
    buffer_load_dwordx4 v1, s[12:15], s93 offen offset:0 nt lds
    buffer_load_dwordx4 v2, s[12:15], s93 offen offset:1024 nt lds
    buffer_load_dwordx4 v3, s[12:15], s93 offen offset:2048 nt lds
    s_call_b64 s[40:41], F_wait
    s_mul_i32 s50, s33, 1
    s_add_u32 s50, s50, s48
    s_mov_b32 m0, 73728
    s_add_u32 s93, s50, 3072
    buffer_load_dwordx4 v1, s[12:15], s50 offen offset:0 nt lds
    buffer_load_dwordx4 v2, s[12:15], s50 offen offset:1024 nt lds
    buffer_load_dwordx4 v3, s[12:15], s50 offen offset:2048 nt lds
    s_call_b64 s[40:41], F_wait
    s_mov_b32 m0, 76800
    s_nop 0
    buffer_load_dwordx4 v1, s[12:15], s93 offen offset:0 nt lds
    buffer_load_dwordx4 v2, s[12:15], s93 offen offset:1024 nt lds
    buffer_load_dwordx4 v3, s[12:15], s93 offen offset:2048 nt lds
    s_call_b64 s[40:41], F_wait
    s_mul_i32 s50, s33, 2
    s_add_u32 s50, s50, s48
    s_mov_b32 m0, 79872
    s_add_u32 s93, s50, 3072
    buffer_load_dwordx4 v1, s[12:15], s50 offen offset:0 nt lds
    buffer_load_dwordx4 v2, s[12:15], s50 offen offset:1024 nt lds
    buffer_load_dwordx4 v3, s[12:15], s50 offen offset:2048 nt lds
    s_call_b64 s[40:41], F_wait
    s_mov_b32 m0, 82944
    s_nop 0
    buffer_load_dwordx4 v1, s[12:15], s93 offen offset:0 nt lds
    buffer_load_dwordx4 v2, s[12:15], s93 offen offset:1024 nt lds
    buffer_load_dwordx4 v3, s[12:15], s93 offen offset:2048 nt lds
    s_call_b64 s[40:41], F_wait
    s_mul_i32 s50, s33, 2
    s_add_u32 s50, s50, s48
    s_mov_b32 m0, 122880
    s_add_u32 s93, s50, 3072
    buffer_load_dwordx4 v1, s[4:7], s50 offen offset:0 nt lds
    buffer_load_dwordx4 v2, s[4:7], s50 offen offset:1024 nt lds
    buffer_load_dwordx4 v3, s[4:7], s50 offen offset:2048 nt lds
    s_call_b64 s[40:41], F_wait
    s_mov_b32 m0, 125952
    s_nop 0
    buffer_load_dwordx4 v1, s[4:7], s93 offen offset:0 nt lds
    buffer_load_dwordx4 v2, s[4:7], s93 offen offset:1024 nt lds
    buffer_load_dwordx4 v3, s[4:7], s93 offen offset:2048 nt lds
    s_call_b64 s[40:41], F_wait
    s_mul_i32 s50, s33, 4
    s_add_u32 s50, s50, s48
    s_mov_b32 m0, 36864
    s_add_u32 s93, s50, 3072
    buffer_load_dwordx4 v1, s[8:11], s50 offen offset:0 nt lds
    buffer_load_dwordx4 v2, s[8:11], s50 offen offset:1024 nt lds
    buffer_load_dwordx4 v3, s[8:11], s50 offen offset:2048 nt lds
    s_call_b64 s[40:41], F_wait
    s_mov_b32 m0, 39936
    s_nop 0
    buffer_load_dwordx4 v1, s[8:11], s93 offen offset:0 nt lds
    buffer_load_dwordx4 v2, s[8:11], s93 offen offset:1024 nt lds
    buffer_load_dwordx4 v3, s[8:11], s93 offen offset:2048 nt lds
    s_call_b64 s[40:41], F_wait
    s_mul_i32 s50, s33, 3
    s_add_u32 s50, s50, s48
    s_mov_b32 m0, 86016
    s_add_u32 s93, s50, 3072
    buffer_load_dwordx4 v1, s[12:15], s50 offen offset:0 nt lds
    buffer_load_dwordx4 v2, s[12:15], s50 offen offset:1024 nt lds
    buffer_load_dwordx4 v3, s[12:15], s50 offen offset:2048 nt lds
    s_call_b64 s[40:41], F_wait
    s_mov_b32 m0, 89088
    s_nop 0
    buffer_load_dwordx4 v1, s[12:15], s93 offen offset:0 nt lds
    buffer_load_dwordx4 v2, s[12:15], s93 offen offset:1024 nt lds
    buffer_load_dwordx4 v3, s[12:15], s93 offen offset:2048 nt lds
    s_call_b64 s[40:41], F_wait
    s_mul_i32 s50, s33, 3
    s_add_u32 s50, s50, s48
    s_mov_b32 m0, 129024
    s_add_u32 s93, s50, 3072
    buffer_load_dwordx4 v1, s[4:7], s50 offen offset:0 nt lds
    buffer_load_dwordx4 v2, s[4:7], s50 offen offset:1024 nt lds
    buffer_load_dwordx4 v3, s[4:7], s50 offen offset:2048 nt lds
    s_call_b64 s[40:41], F_wait
    s_mov_b32 m0, 132096
    s_nop 0
    buffer_load_dwordx4 v1, s[4:7], s93 offen offset:0 nt lds
    buffer_load_dwordx4 v2, s[4:7], s93 offen offset:1024 nt lds
    buffer_load_dwordx4 v3, s[4:7], s93 offen offset:2048 nt lds
    s_call_b64 s[40:41], F_wait
    s_mul_i32 s50, s33, 5
    s_add_u32 s50, s50, s48
    s_mov_b32 m0, 43008
    s_add_u32 s93, s50, 3072
    buffer_load_dwordx4 v1, s[8:11], s50 offen offset:0 nt lds
    buffer_load_dwordx4 v2, s[8:11], s50 offen offset:1024 nt lds
    buffer_load_dwordx4 v3, s[8:11], s50 offen offset:2048 nt lds
    s_call_b64 s[40:41], F_wait
    s_mov_b32 m0, 46080
    s_nop 0
    buffer_load_dwordx4 v1, s[8:11], s93 offen offset:0 nt lds
    buffer_load_dwordx4 v2, s[8:11], s93 offen offset:1024 nt lds
    buffer_load_dwordx4 v3, s[8:11], s93 offen offset:2048 nt lds
    s_call_b64 s[40:41], F_wait
    s_mul_i32 s50, s33, 4
    s_add_u32 s50, s50, s48
    s_mov_b32 m0, 92160
    s_add_u32 s93, s50, 3072
    buffer_load_dwordx4 v1, s[12:15], s50 offen offset:0 nt lds
    buffer_load_dwordx4 v2, s[12:15], s50 offen offset:1024 nt lds
    buffer_load_dwordx4 v3, s[12:15], s50 offen offset:2048 nt lds
    s_call_b64 s[40:41], F_wait
    s_mov_b32 m0, 95232
    s_nop 0
    buffer_load_dwordx4 v1, s[12:15], s93 offen offset:0 nt lds
    buffer_load_dwordx4 v2, s[12:15], s93 offen offset:1024 nt lds
    buffer_load_dwordx4 v3, s[12:15], s93 offen offset:2048 nt lds
    s_call_b64 s[40:41], F_wait
    v_writelane_b32 v5, 1, 28
L_fr1:
    v_cmp_lt_u32 vcc, v6, v5
    s_nop 1
    s_cbranch_vccz L_ok1
    ds_read_b32 v6, v7
    s_sub_u32 s46, s46, 1
    s_waitcnt lgkmcnt(0)
    s_cbranch_scc0 L_fr1
    s_mov_b32 s46, 0
L_ok1:
    s_mul_i32 s50, s33, 4
    s_add_u32 s50, s50, s48
    s_mov_b32 m0, 110592
    s_add_u32 s93, s50, 3072
    buffer_load_dwordx4 v1, s[4:7], s50 offen offset:0 nt lds
    buffer_load_dwordx4 v2, s[4:7], s50 offen offset:1024 nt lds
    buffer_load_dwordx4 v3, s[4:7], s50 offen offset:2048 nt lds
    s_call_b64 s[40:41], F_wait
    s_mov_b32 m0, 113664
    s_nop 0
    buffer_load_dwordx4 v1, s[4:7], s93 offen offset:0 nt lds
    buffer_load_dwordx4 v2, s[4:7], s93 offen offset:1024 nt lds
    buffer_load_dwordx4 v3, s[4:7], s93 offen offset:2048 nt lds
    s_call_b64 s[40:41], F_wait
    s_mul_i32 s50, s33, 6
    s_add_u32 s50, s50, s48
    s_mov_b32 m0, 49152
    s_add_u32 s93, s50, 3072
    buffer_load_dwordx4 v1, s[8:11], s50 offen offset:0 nt lds
    buffer_load_dwordx4 v2, s[8:11], s50 offen offset:1024 nt lds
    buffer_load_dwordx4 v3, s[8:11], s50 offen offset:2048 nt lds
    s_call_b64 s[40:41], F_wait
    s_mov_b32 m0, 52224
    s_nop 0
    buffer_load_dwordx4 v1, s[8:11], s93 offen offset:0 nt lds
    buffer_load_dwordx4 v2, s[8:11], s93 offen offset:1024 nt lds
    buffer_load_dwordx4 v3, s[8:11], s93 offen offset:2048 nt lds
    s_call_b64 s[40:41], F_wait
    s_mul_i32 s50, s33, 5
    s_add_u32 s50, s50, s48
    s_mov_b32 m0, 98304
    s_add_u32 s93, s50, 3072
    buffer_load_dwordx4 v1, s[12:15], s50 offen offset:0 nt lds
    buffer_load_dwordx4 v2, s[12:15], s50 offen offset:1024 nt lds
    buffer_load_dwordx4 v3, s[12:15], s50 offen offset:2048 nt lds
    s_call_b64 s[40:41], F_wait
    s_mov_b32 m0, 101376
    s_nop 0
    buffer_load_dwordx4 v1, s[12:15], s93 offen offset:0 nt lds
    buffer_load_dwordx4 v2, s[12:15], s93 offen offset:1024 nt lds
    buffer_load_dwordx4 v3, s[12:15], s93 offen offset:2048 nt lds
    s_call_b64 s[40:41], F_wait
    v_writelane_b32 v5, 1, 29
L_fr2:
    v_cmp_lt_u32 vcc, v6, v5
    s_nop 1
    s_cbranch_vccz L_ok2
    ds_read_b32 v6, v7
    s_sub_u32 s46, s46, 1
    s_waitcnt lgkmcnt(0)
    s_cbranch_scc0 L_fr2
    s_mov_b32 s46, 0
L_ok2:
    s_mul_i32 s50, s33, 5
    s_add_u32 s50, s50, s48
    s_mov_b32 m0, 116736
    s_add_u32 s93, s50, 3072
    buffer_load_dwordx4 v1, s[4:7], s50 offen offset:0 nt lds
    buffer_load_dwordx4 v2, s[4:7], s50 offen offset:1024 nt lds
    buffer_load_dwordx4 v3, s[4:7], s50 offen offset:2048 nt lds
    s_call_b64 s[40:41], F_wait
    s_mov_b32 m0, 119808
    s_nop 0
    buffer_load_dwordx4 v1, s[4:7], s93 offen offset:0 nt lds
    buffer_load_dwordx4 v2, s[4:7], s93 offen offset:1024 nt lds
    buffer_load_dwordx4 v3, s[4:7], s93 offen offset:2048 nt lds
    s_call_b64 s[40:41], F_wait
    v_writelane_b32 v5, 1, 0
L_fr3:
    v_cmp_lt_u32 vcc, v6, v5
    s_nop 1
    s_cbranch_vccz L_ok3
    ds_read_b32 v6, v7
    s_sub_u32 s46, s46, 1
    s_waitcnt lgkmcnt(0)
    s_cbranch_scc0 L_fr3
    s_mov_b32 s46, 0
L_ok3:
    s_mul_i32 s50, s33, 7
    s_add_u32 s50, s50, s48
    s_mov_b32 m0, 0
    s_add_u32 s93, s50, 3072
    buffer_load_dwordx4 v1, s[8:11], s50 offen offset:0 nt lds
    buffer_load_dwordx4 v2, s[8:11], s50 offen offset:1024 nt lds
    buffer_load_dwordx4 v3, s[8:11], s50 offen offset:2048 nt lds
    s_call_b64 s[40:41], F_wait
    s_mov_b32 m0, 3072
    s_nop 0
    buffer_load_dwordx4 v1, s[8:11], s93 offen offset:0 nt lds
    buffer_load_dwordx4 v2, s[8:11], s93 offen offset:1024 nt lds
    buffer_load_dwordx4 v3, s[8:11], s93 offen offset:2048 nt lds
    s_call_b64 s[40:41], F_wait
    s_mul_i32 s50, s33, 6
    s_add_u32 s50, s50, s48
    s_mov_b32 m0, 104448
    s_add_u32 s93, s50, 3072
    buffer_load_dwordx4 v1, s[12:15], s50 offen offset:0 nt lds
    buffer_load_dwordx4 v2, s[12:15], s50 offen offset:1024 nt lds
    buffer_load_dwordx4 v3, s[12:15], s50 offen offset:2048 nt lds
    s_call_b64 s[40:41], F_wait
    s_mov_b32 m0, 107520
    s_nop 0
    buffer_load_dwordx4 v1, s[12:15], s93 offen offset:0 nt lds
    buffer_load_dwordx4 v2, s[12:15], s93 offen offset:1024 nt lds
    buffer_load_dwordx4 v3, s[12:15], s93 offen offset:2048 nt lds
    s_call_b64 s[40:41], F_wait
    v_writelane_b32 v5, 1, 30
L_fr4:
    v_cmp_lt_u32 vcc, v6, v5
    s_nop 1
    s_cbranch_vccz L_ok4
    ds_read_b32 v6, v7
    s_sub_u32 s46, s46, 1
    s_waitcnt lgkmcnt(0)
    s_cbranch_scc0 L_fr4
    s_mov_b32 s46, 0
L_ok4:
    s_mul_i32 s50, s33, 6
    s_add_u32 s50, s50, s48
    s_mov_b32 m0, 122880
    s_add_u32 s93, s50, 3072
    buffer_load_dwordx4 v1, s[4:7], s50 offen offset:0 nt lds
    buffer_load_dwordx4 v2, s[4:7], s50 offen offset:1024 nt lds
    buffer_load_dwordx4 v3, s[4:7], s50 offen offset:2048 nt lds
    s_call_b64 s[40:41], F_wait
    s_mov_b32 m0, 125952
    s_nop 0
    buffer_load_dwordx4 v1, s[4:7], s93 offen offset:0 nt lds
    buffer_load_dwordx4 v2, s[4:7], s93 offen offset:1024 nt lds
    buffer_load_dwordx4 v3, s[4:7], s93 offen offset:2048 nt lds
    s_call_b64 s[40:41], F_wait
    v_writelane_b32 v5, 1, 1
L_fr5:
    v_cmp_lt_u32 vcc, v6, v5
    s_nop 1
    s_cbranch_vccz L_ok5
    ds_read_b32 v6, v7
    s_sub_u32 s46, s46, 1
    s_waitcnt lgkmcnt(0)
    s_cbranch_scc0 L_fr5
    s_mov_b32 s46, 0
L_ok5:
    s_mul_i32 s50, s33, 8
    s_add_u32 s50, s50, s48
    s_mov_b32 m0, 6144
    s_add_u32 s93, s50, 3072
    buffer_load_dwordx4 v1, s[8:11], s50 offen offset:0 nt lds
    buffer_load_dwordx4 v2, s[8:11], s50 offen offset:1024 nt lds
    buffer_load_dwordx4 v3, s[8:11], s50 offen offset:2048 nt lds
    s_call_b64 s[40:41], F_wait
    s_mov_b32 m0, 9216
    s_nop 0
    buffer_load_dwordx4 v1, s[8:11], s93 offen offset:0 nt lds
    buffer_load_dwordx4 v2, s[8:11], s93 offen offset:1024 nt lds
    buffer_load_dwordx4 v3, s[8:11], s93 offen offset:2048 nt lds
    s_call_b64 s[40:41], F_wait
    v_writelane_b32 v5, 1, 8
L_fr6:
    v_cmp_lt_u32 vcc, v6, v5
    s_nop 1
    s_cbranch_vccz L_ok6
    ds_read_b32 v6, v7
    s_sub_u32 s46, s46, 1
    s_waitcnt lgkmcnt(0)
    s_cbranch_scc0 L_fr6
    s_mov_b32 s46, 0
L_ok6:
    s_mul_i32 s50, s33, 7
    s_add_u32 s50, s50, s48
    s_mov_b32 m0, 55296
    s_add_u32 s93, s50, 3072
    buffer_load_dwordx4 v1, s[12:15], s50 offen offset:0 nt lds
    buffer_load_dwordx4 v2, s[12:15], s50 offen offset:1024 nt lds
    buffer_load_dwordx4 v3, s[12:15], s50 offen offset:2048 nt lds
    s_call_b64 s[40:41], F_wait
    s_mov_b32 m0, 58368
    s_nop 0
    buffer_load_dwordx4 v1, s[12:15], s93 offen offset:0 nt lds
    buffer_load_dwordx4 v2, s[12:15], s93 offen offset:1024 nt lds
    buffer_load_dwordx4 v3, s[12:15], s93 offen offset:2048 nt lds
    s_call_b64 s[40:41], F_wait
    v_writelane_b32 v5, 1, 31
L_fr7:
    v_cmp_lt_u32 vcc, v6, v5
    s_nop 1
    s_cbranch_vccz L_ok7
    ds_read_b32 v6, v7
    s_sub_u32 s46, s46, 1
    s_waitcnt lgkmcnt(0)
    s_cbranch_scc0 L_fr7
    s_mov_b32 s46, 0
L_ok7:
    s_mul_i32 s50, s33, 7
    s_add_u32 s50, s50, s48
    s_mov_b32 m0, 129024
    s_add_u32 s93, s50, 3072
    buffer_load_dwordx4 v1, s[4:7], s50 offen offset:0 nt lds
    buffer_load_dwordx4 v2, s[4:7], s50 offen offset:1024 nt lds
    buffer_load_dwordx4 v3, s[4:7], s50 offen offset:2048 nt lds
    s_call_b64 s[40:41], F_wait
    s_mov_b32 m0, 132096
    s_nop 0
    buffer_load_dwordx4 v1, s[4:7], s93 offen offset:0 nt lds
    buffer_load_dwordx4 v2, s[4:7], s93 offen offset:1024 nt lds
    buffer_load_dwordx4 v3, s[4:7], s93 offen offset:2048 nt lds
    s_call_b64 s[40:41], F_wait
    v_writelane_b32 v5, 1, 2
    v_writelane_b32 v5, 1, 4
L_fr8:
    v_cmp_lt_u32 vcc, v6, v5
    s_nop 1
    s_cbranch_vccz L_ok8
    ds_read_b32 v6, v7
    s_sub_u32 s46, s46, 1
    s_waitcnt lgkmcnt(0)
    s_cbranch_scc0 L_fr8
    s_mov_b32 s46, 0
L_ok8:
    s_mul_i32 s50, s33, 9
    s_add_u32 s50, s50, s48
    s_mov_b32 m0, 12288
    s_add_u32 s93, s50, 3072
    buffer_load_dwordx4 v1, s[8:11], s50 offen offset:0 nt lds
    buffer_load_dwordx4 v2, s[8:11], s50 offen offset:1024 nt lds
    buffer_load_dwordx4 v3, s[8:11], s50 offen offset:2048 nt lds
    s_call_b64 s[40:41], F_wait
    s_mov_b32 m0, 15360
    s_nop 0
    buffer_load_dwordx4 v1, s[8:11], s93 offen offset:0 nt lds
    buffer_load_dwordx4 v2, s[8:11], s93 offen offset:1024 nt lds
    buffer_load_dwordx4 v3, s[8:11], s93 offen offset:2048 nt lds
    s_call_b64 s[40:41], F_wait
    v_writelane_b32 v5, 1, 9
L_fr9:
    v_cmp_lt_u32 vcc, v6, v5
    s_nop 1
    s_cbranch_vccz L_ok9
    ds_read_b32 v6, v7
    s_sub_u32 s46, s46, 1
    s_waitcnt lgkmcnt(0)
    s_cbranch_scc0 L_fr9
    s_mov_b32 s46, 0
L_ok9:
    s_mul_i32 s50, s33, 8
    s_add_u32 s50, s50, s48
    s_mov_b32 m0, 61440
    s_add_u32 s93, s50, 3072
    buffer_load_dwordx4 v1, s[12:15], s50 offen offset:0 nt lds
    buffer_load_dwordx4 v2, s[12:15], s50 offen offset:1024 nt lds
    buffer_load_dwordx4 v3, s[12:15], s50 offen offset:2048 nt lds
    s_call_b64 s[40:41], F_wait
    s_mov_b32 m0, 64512
    s_nop 0
    buffer_load_dwordx4 v1, s[12:15], s93 offen offset:0 nt lds
    buffer_load_dwordx4 v2, s[12:15], s93 offen offset:1024 nt lds
    buffer_load_dwordx4 v3, s[12:15], s93 offen offset:2048 nt lds
    s_call_b64 s[40:41], F_wait
    v_writelane_b32 v5, 2, 28
L_fr10:
    v_cmp_lt_u32 vcc, v6, v5
    s_nop 1
    s_cbranch_vccz L_ok10
    ds_read_b32 v6, v7
    s_sub_u32 s46, s46, 1
    s_waitcnt lgkmcnt(0)
    s_cbranch_scc0 L_fr10
    s_mov_b32 s46, 0
L_ok10:
    s_mul_i32 s50, s33, 8
    s_add_u32 s50, s50, s48
    s_mov_b32 m0, 110592
    s_add_u32 s93, s50, 3072
    buffer_load_dwordx4 v1, s[4:7], s50 offen offset:0 nt lds
    buffer_load_dwordx4 v2, s[4:7], s50 offen offset:1024 nt lds
    buffer_load_dwordx4 v3, s[4:7], s50 offen offset:2048 nt lds
    s_call_b64 s[40:41], F_wait
    s_mov_b32 m0, 113664
    s_nop 0
    buffer_load_dwordx4 v1, s[4:7], s93 offen offset:0 nt lds
    buffer_load_dwordx4 v2, s[4:7], s93 offen offset:1024 nt lds
    buffer_load_dwordx4 v3, s[4:7], s93 offen offset:2048 nt lds
    s_call_b64 s[40:41], F_wait
    v_writelane_b32 v5, 1, 3
L_fr11:
    v_cmp_lt_u32 vcc, v6, v5
    s_nop 1
    s_cbranch_vccz L_ok11
    ds_read_b32 v6, v7
    s_sub_u32 s46, s46, 1
    s_waitcnt lgkmcnt(0)
    s_cbranch_scc0 L_fr11
    s_mov_b32 s46, 0
L_ok11:
    s_mul_i32 s50, s33, 10
    s_add_u32 s50, s50, s48
    s_mov_b32 m0, 18432
    s_add_u32 s93, s50, 3072
    buffer_load_dwordx4 v1, s[8:11], s50 offen offset:0 nt lds
    buffer_load_dwordx4 v2, s[8:11], s50 offen offset:1024 nt lds
    buffer_load_dwordx4 v3, s[8:11], s50 offen offset:2048 nt lds
    s_call_b64 s[40:41], F_wait
    s_mov_b32 m0, 21504
    s_nop 0
    buffer_load_dwordx4 v1, s[8:11], s93 offen offset:0 nt lds
    buffer_load_dwordx4 v2, s[8:11], s93 offen offset:1024 nt lds
    buffer_load_dwordx4 v3, s[8:11], s93 offen offset:2048 nt lds
    s_call_b64 s[40:41], F_wait
    v_writelane_b32 v5, 1, 10
    v_writelane_b32 v5, 1, 12
L_fr12:
    v_cmp_lt_u32 vcc, v6, v5
    s_nop 1
    s_cbranch_vccz L_ok12
    ds_read_b32 v6, v7
    s_sub_u32 s46, s46, 1
    s_waitcnt lgkmcnt(0)
    s_cbranch_scc0 L_fr12
    s_mov_b32 s46, 0
L_ok12:
    s_mul_i32 s50, s33, 9
    s_add_u32 s50, s50, s48
    s_mov_b32 m0, 67584
    s_add_u32 s93, s50, 3072
    buffer_load_dwordx4 v1, s[12:15], s50 offen offset:0 nt lds
    buffer_load_dwordx4 v2, s[12:15], s50 offen offset:1024 nt lds
    buffer_load_dwordx4 v3, s[12:15], s50 offen offset:2048 nt lds
    s_call_b64 s[40:41], F_wait
    s_mov_b32 m0, 70656
    s_nop 0
    buffer_load_dwordx4 v1, s[12:15], s93 offen offset:0 nt lds
    buffer_load_dwordx4 v2, s[12:15], s93 offen offset:1024 nt lds
    buffer_load_dwordx4 v3, s[12:15], s93 offen offset:2048 nt lds
    s_call_b64 s[40:41], F_wait
    v_writelane_b32 v5, 2, 29
L_fr13:
    v_cmp_lt_u32 vcc, v6, v5
    s_nop 1
    s_cbranch_vccz L_ok13
    ds_read_b32 v6, v7
    s_sub_u32 s46, s46, 1
    s_waitcnt lgkmcnt(0)
    s_cbranch_scc0 L_fr13
    s_mov_b32 s46, 0
L_ok13:
    s_mul_i32 s50, s33, 9
    s_add_u32 s50, s50, s48
    s_mov_b32 m0, 116736
    s_add_u32 s93, s50, 3072
    buffer_load_dwordx4 v1, s[4:7], s50 offen offset:0 nt lds
    buffer_load_dwordx4 v2, s[4:7], s50 offen offset:1024 nt lds
    buffer_load_dwordx4 v3, s[4:7], s50 offen offset:2048 nt lds
    s_call_b64 s[40:41], F_wait
    s_mov_b32 m0, 119808
    s_nop 0
    buffer_load_dwordx4 v1, s[4:7], s93 offen offset:0 nt lds
    buffer_load_dwordx4 v2, s[4:7], s93 offen offset:1024 nt lds
    buffer_load_dwordx4 v3, s[4:7], s93 offen offset:2048 nt lds
    s_call_b64 s[40:41], F_wait
    v_writelane_b32 v5, 2, 0
    v_writelane_b32 v5, 2, 4
L_fr14:
    v_cmp_lt_u32 vcc, v6, v5
    s_nop 1
    s_cbranch_vccz L_ok14
    ds_read_b32 v6, v7
    s_sub_u32 s46, s46, 1
    s_waitcnt lgkmcnt(0)
    s_cbranch_scc0 L_fr14
    s_mov_b32 s46, 0
L_ok14:
    s_mul_i32 s50, s33, 11
    s_add_u32 s50, s50, s48
    s_mov_b32 m0, 24576
    s_add_u32 s93, s50, 3072
    buffer_load_dwordx4 v1, s[8:11], s50 offen offset:0 nt lds
    buffer_load_dwordx4 v2, s[8:11], s50 offen offset:1024 nt lds
    buffer_load_dwordx4 v3, s[8:11], s50 offen offset:2048 nt lds
    s_call_b64 s[40:41], F_wait
    s_mov_b32 m0, 27648
    s_nop 0
    buffer_load_dwordx4 v1, s[8:11], s93 offen offset:0 nt lds
    buffer_load_dwordx4 v2, s[8:11], s93 offen offset:1024 nt lds
    buffer_load_dwordx4 v3, s[8:11], s93 offen offset:2048 nt lds
    s_call_b64 s[40:41], F_wait
    v_writelane_b32 v5, 1, 11
L_fr15:
    v_cmp_lt_u32 vcc, v6, v5
    s_nop 1
    s_cbranch_vccz L_ok15
    ds_read_b32 v6, v7
    s_sub_u32 s46, s46, 1
    s_waitcnt lgkmcnt(0)
    s_cbranch_scc0 L_fr15
    s_mov_b32 s46, 0
L_ok15:
    s_mul_i32 s50, s33, 10
    s_add_u32 s50, s50, s48
    s_mov_b32 m0, 73728
    s_add_u32 s93, s50, 3072
    buffer_load_dwordx4 v1, s[12:15], s50 offen offset:0 nt lds
    buffer_load_dwordx4 v2, s[12:15], s50 offen offset:1024 nt lds
    buffer_load_dwordx4 v3, s[12:15], s50 offen offset:2048 nt lds
    s_call_b64 s[40:41], F_wait
    s_mov_b32 m0, 76800
    s_nop 0
    buffer_load_dwordx4 v1, s[12:15], s93 offen offset:0 nt lds
    buffer_load_dwordx4 v2, s[12:15], s93 offen offset:1024 nt lds
    buffer_load_dwordx4 v3, s[12:15], s93 offen offset:2048 nt lds
    s_call_b64 s[40:41], F_wait
    v_writelane_b32 v5, 2, 8
    v_writelane_b32 v5, 2, 12
L_fr16:
    v_cmp_lt_u32 vcc, v6, v5
    s_nop 1
    s_cbranch_vccz L_ok16
    ds_read_b32 v6, v7
    s_sub_u32 s46, s46, 1
    s_waitcnt lgkmcnt(0)
    s_cbranch_scc0 L_fr16
    s_mov_b32 s46, 0
L_ok16:
    s_mul_i32 s50, s33, 11
    s_add_u32 s50, s50, s48
    s_mov_b32 m0, 79872
    s_add_u32 s93, s50, 3072
    buffer_load_dwordx4 v1, s[12:15], s50 offen offset:0 nt lds
    buffer_load_dwordx4 v2, s[12:15], s50 offen offset:1024 nt lds
    buffer_load_dwordx4 v3, s[12:15], s50 offen offset:2048 nt lds
    s_call_b64 s[40:41], F_wait
    s_mov_b32 m0, 82944
    s_nop 0
    buffer_load_dwordx4 v1, s[12:15], s93 offen offset:0 nt lds
    buffer_load_dwordx4 v2, s[12:15], s93 offen offset:1024 nt lds
    buffer_load_dwordx4 v3, s[12:15], s93 offen offset:2048 nt lds
    s_call_b64 s[40:41], F_wait
    v_writelane_b32 v5, 2, 1
L_fr17:
    v_cmp_lt_u32 vcc, v6, v5
    s_nop 1
    s_cbranch_vccz L_ok17
    ds_read_b32 v6, v7
    s_sub_u32 s46, s46, 1
    s_waitcnt lgkmcnt(0)
    s_cbranch_scc0 L_fr17
    s_mov_b32 s46, 0
L_ok17:
    s_mul_i32 s50, s33, 12
    s_add_u32 s50, s50, s48
    s_mov_b32 m0, 30720
    s_add_u32 s93, s50, 3072
    buffer_load_dwordx4 v1, s[8:11], s50 offen offset:0 nt lds
    buffer_load_dwordx4 v2, s[8:11], s50 offen offset:1024 nt lds
    buffer_load_dwordx4 v3, s[8:11], s50 offen offset:2048 nt lds
    s_call_b64 s[40:41], F_wait
    s_mov_b32 m0, 33792
    s_nop 0
    buffer_load_dwordx4 v1, s[8:11], s93 offen offset:0 nt lds
    buffer_load_dwordx4 v2, s[8:11], s93 offen offset:1024 nt lds
    buffer_load_dwordx4 v3, s[8:11], s93 offen offset:2048 nt lds
    s_call_b64 s[40:41], F_wait
    v_writelane_b32 v5, 2, 30
L_fr18:
    v_cmp_lt_u32 vcc, v6, v5
    s_nop 1
    s_cbranch_vccz L_ok18
    ds_read_b32 v6, v7
    s_sub_u32 s46, s46, 1
    s_waitcnt lgkmcnt(0)
    s_cbranch_scc0 L_fr18
    s_mov_b32 s46, 0
L_ok18:
    s_mul_i32 s50, s33, 10
    s_add_u32 s50, s50, s48
    s_mov_b32 m0, 122880
    s_add_u32 s93, s50, 3072
    buffer_load_dwordx4 v1, s[4:7], s50 offen offset:0 nt lds
    buffer_load_dwordx4 v2, s[4:7], s50 offen offset:1024 nt lds
    buffer_load_dwordx4 v3, s[4:7], s50 offen offset:2048 nt lds
    s_call_b64 s[40:41], F_wait
    s_mov_b32 m0, 125952
    s_nop 0
    buffer_load_dwordx4 v1, s[4:7], s93 offen offset:0 nt lds
    buffer_load_dwordx4 v2, s[4:7], s93 offen offset:1024 nt lds
    buffer_load_dwordx4 v3, s[4:7], s93 offen offset:2048 nt lds
    s_call_b64 s[40:41], F_wait
    v_writelane_b32 v5, 2, 2
    v_writelane_b32 v5, 3, 4
L_fr19:
    v_cmp_lt_u32 vcc, v6, v5
    s_nop 1
    s_cbranch_vccz L_ok19
    ds_read_b32 v6, v7
    s_sub_u32 s46, s46, 1
    s_waitcnt lgkmcnt(0)
    s_cbranch_scc0 L_fr19
    s_mov_b32 s46, 0
L_ok19:
    s_mul_i32 s50, s33, 13
    s_add_u32 s50, s50, s48
    s_mov_b32 m0, 36864
    s_add_u32 s93, s50, 3072
    buffer_load_dwordx4 v1, s[8:11], s50 offen offset:0 nt lds
    buffer_load_dwordx4 v2, s[8:11], s50 offen offset:1024 nt lds
    buffer_load_dwordx4 v3, s[8:11], s50 offen offset:2048 nt lds
    s_call_b64 s[40:41], F_wait
    s_mov_b32 m0, 39936
    s_nop 0
    buffer_load_dwordx4 v1, s[8:11], s93 offen offset:0 nt lds
    buffer_load_dwordx4 v2, s[8:11], s93 offen offset:1024 nt lds
    buffer_load_dwordx4 v3, s[8:11], s93 offen offset:2048 nt lds
    s_call_b64 s[40:41], F_wait
    v_writelane_b32 v5, 2, 9
L_fr20:
    v_cmp_lt_u32 vcc, v6, v5
    s_nop 1
    s_cbranch_vccz L_ok20
    ds_read_b32 v6, v7
    s_sub_u32 s46, s46, 1
    s_waitcnt lgkmcnt(0)
    s_cbranch_scc0 L_fr20
    s_mov_b32 s46, 0
L_ok20:
    s_mul_i32 s50, s33, 12
    s_add_u32 s50, s50, s48
    s_mov_b32 m0, 86016
    s_add_u32 s93, s50, 3072
    buffer_load_dwordx4 v1, s[12:15], s50 offen offset:0 nt lds
    buffer_load_dwordx4 v2, s[12:15], s50 offen offset:1024 nt lds
    buffer_load_dwordx4 v3, s[12:15], s50 offen offset:2048 nt lds
    s_call_b64 s[40:41], F_wait
    s_mov_b32 m0, 89088
    s_nop 0
    buffer_load_dwordx4 v1, s[12:15], s93 offen offset:0 nt lds
    buffer_load_dwordx4 v2, s[12:15], s93 offen offset:1024 nt lds
    buffer_load_dwordx4 v3, s[12:15], s93 offen offset:2048 nt lds
    s_call_b64 s[40:41], F_wait
    v_writelane_b32 v5, 2, 10
    v_writelane_b32 v5, 3, 12
L_fr21:
    v_cmp_lt_u32 vcc, v6, v5
    s_nop 1
    s_cbranch_vccz L_ok21
    ds_read_b32 v6, v7
    s_sub_u32 s46, s46, 1
    s_waitcnt lgkmcnt(0)
    s_cbranch_scc0 L_fr21
    s_mov_b32 s46, 0
L_ok21:
    s_mul_i32 s50, s33, 13
    s_add_u32 s50, s50, s48
    s_mov_b32 m0, 92160
    s_add_u32 s93, s50, 3072
    buffer_load_dwordx4 v1, s[12:15], s50 offen offset:0 nt lds
    buffer_load_dwordx4 v2, s[12:15], s50 offen offset:1024 nt lds
    buffer_load_dwordx4 v3, s[12:15], s50 offen offset:2048 nt lds
    s_call_b64 s[40:41], F_wait
    s_mov_b32 m0, 95232
    s_nop 0
    buffer_load_dwordx4 v1, s[12:15], s93 offen offset:0 nt lds
    buffer_load_dwordx4 v2, s[12:15], s93 offen offset:1024 nt lds
    buffer_load_dwordx4 v3, s[12:15], s93 offen offset:2048 nt lds
    s_call_b64 s[40:41], F_wait
    v_writelane_b32 v5, 2, 31
L_fr22:
    v_cmp_lt_u32 vcc, v6, v5
    s_nop 1
    s_cbranch_vccz L_ok22
    ds_read_b32 v6, v7
    s_sub_u32 s46, s46, 1
    s_waitcnt lgkmcnt(0)
    s_cbranch_scc0 L_fr22
    s_mov_b32 s46, 0
L_ok22:
    s_mul_i32 s50, s33, 11
    s_add_u32 s50, s50, s48
    s_mov_b32 m0, 129024
    s_add_u32 s93, s50, 3072
    buffer_load_dwordx4 v1, s[4:7], s50 offen offset:0 nt lds
    buffer_load_dwordx4 v2, s[4:7], s50 offen offset:1024 nt lds
    buffer_load_dwordx4 v3, s[4:7], s50 offen offset:2048 nt lds
    s_call_b64 s[40:41], F_wait
    s_mov_b32 m0, 132096
    s_nop 0
    buffer_load_dwordx4 v1, s[4:7], s93 offen offset:0 nt lds
    buffer_load_dwordx4 v2, s[4:7], s93 offen offset:1024 nt lds
    buffer_load_dwordx4 v3, s[4:7], s93 offen offset:2048 nt lds
    s_call_b64 s[40:41], F_wait
    v_writelane_b32 v5, 2, 3
L_fr23:
    v_cmp_lt_u32 vcc, v6, v5
    s_nop 1
    s_cbranch_vccz L_ok23
    ds_read_b32 v6, v7
    s_sub_u32 s46, s46, 1
    s_waitcnt lgkmcnt(0)
    s_cbranch_scc0 L_fr23
    s_mov_b32 s46, 0
L_ok23:
    s_mul_i32 s50, s33, 14
    s_add_u32 s50, s50, s48
    s_mov_b32 m0, 43008
    s_add_u32 s93, s50, 3072
    buffer_load_dwordx4 v1, s[8:11], s50 offen offset:0 lds
    buffer_load_dwordx4 v2, s[8:11], s50 offen offset:1024 lds
    buffer_load_dwordx4 v3, s[8:11], s50 offen offset:2048 lds
    s_call_b64 s[40:41], F_wait
    s_mov_b32 m0, 46080
    s_nop 0
    buffer_load_dwordx4 v1, s[8:11], s93 offen offset:0 lds
    buffer_load_dwordx4 v2, s[8:11], s93 offen offset:1024 lds
    buffer_load_dwordx4 v3, s[8:11], s93 offen offset:2048 lds
    s_call_b64 s[40:41], F_wait
    v_writelane_b32 v5, 3, 0
    v_writelane_b32 v5, 4, 4
L_fr24:
    v_cmp_lt_u32 vcc, v6, v5
    s_nop 1
    s_cbranch_vccz L_ok24
    ds_read_b32 v6, v7
    s_sub_u32 s46, s46, 1
    s_waitcnt lgkmcnt(0)
    s_cbranch_scc0 L_fr24
    s_mov_b32 s46, 0
L_ok24:
    s_mul_i32 s50, s33, 15
    s_add_u32 s50, s50, s48
    s_mov_b32 m0, 49152
    s_add_u32 s93, s50, 3072
    buffer_load_dwordx4 v1, s[8:11], s50 offen offset:0 lds
    buffer_load_dwordx4 v2, s[8:11], s50 offen offset:1024 lds
    buffer_load_dwordx4 v3, s[8:11], s50 offen offset:2048 lds
    s_call_b64 s[40:41], F_wait
    s_mov_b32 m0, 52224
    s_nop 0
    buffer_load_dwordx4 v1, s[8:11], s93 offen offset:0 lds
    buffer_load_dwordx4 v2, s[8:11], s93 offen offset:1024 lds
    buffer_load_dwordx4 v3, s[8:11], s93 offen offset:2048 lds
    s_call_b64 s[40:41], F_wait
    v_writelane_b32 v5, 2, 11
L_fr25:
    v_cmp_lt_u32 vcc, v6, v5
    s_nop 1
    s_cbranch_vccz L_ok25
    ds_read_b32 v6, v7
    s_sub_u32 s46, s46, 1
    s_waitcnt lgkmcnt(0)
    s_cbranch_scc0 L_fr25
    s_mov_b32 s46, 0
L_ok25:
    s_mul_i32 s50, s33, 14
    s_add_u32 s50, s50, s48
    s_mov_b32 m0, 98304
    s_add_u32 s93, s50, 3072
    buffer_load_dwordx4 v1, s[12:15], s50 offen offset:0 lds
    buffer_load_dwordx4 v2, s[12:15], s50 offen offset:1024 lds
    buffer_load_dwordx4 v3, s[12:15], s50 offen offset:2048 lds
    s_call_b64 s[40:41], F_wait
    s_mov_b32 m0, 101376
    s_nop 0
    buffer_load_dwordx4 v1, s[12:15], s93 offen offset:0 lds
    buffer_load_dwordx4 v2, s[12:15], s93 offen offset:1024 lds
    buffer_load_dwordx4 v3, s[12:15], s93 offen offset:2048 lds
    s_call_b64 s[40:41], F_wait
    v_writelane_b32 v5, 3, 8
    v_writelane_b32 v5, 4, 12
L_fr26:
    v_cmp_lt_u32 vcc, v6, v5
    s_nop 1
    s_cbranch_vccz L_ok26
    ds_read_b32 v6, v7
    s_sub_u32 s46, s46, 1
    s_waitcnt lgkmcnt(0)
    s_cbranch_scc0 L_fr26
    s_mov_b32 s46, 0
L_ok26:
    s_mul_i32 s50, s33, 15
    s_add_u32 s50, s50, s48
    s_mov_b32 m0, 104448
    s_add_u32 s93, s50, 3072
    buffer_load_dwordx4 v1, s[12:15], s50 offen offset:0 lds
    buffer_load_dwordx4 v2, s[12:15], s50 offen offset:1024 lds
    buffer_load_dwordx4 v3, s[12:15], s50 offen offset:2048 lds
    s_call_b64 s[40:41], F_wait
    s_mov_b32 m0, 107520
    s_nop 0
    buffer_load_dwordx4 v1, s[12:15], s93 offen offset:0 lds
    buffer_load_dwordx4 v2, s[12:15], s93 offen offset:1024 lds
    buffer_load_dwordx4 v3, s[12:15], s93 offen offset:2048 lds
    s_call_b64 s[40:41], F_wait
    v_writelane_b32 v5, 3, 1
L_fr27:
    v_cmp_lt_u32 vcc, v6, v5
    s_nop 1
    s_cbranch_vccz L_ok27
    ds_read_b32 v6, v7
    s_sub_u32 s46, s46, 1
    s_waitcnt lgkmcnt(0)
    s_cbranch_scc0 L_fr27
    s_mov_b32 s46, 0
L_ok27:
    s_mul_i32 s50, s33, 16
    s_add_u32 s50, s50, s48
    s_mov_b32 m0, 0
    s_add_u32 s93, s50, 3072
    buffer_load_dwordx4 v1, s[8:11], s50 offen offset:0 lds
    buffer_load_dwordx4 v2, s[8:11], s50 offen offset:1024 lds
    buffer_load_dwordx4 v3, s[8:11], s50 offen offset:2048 lds
    s_call_b64 s[40:41], F_wait
    s_mov_b32 m0, 3072
    s_nop 0
    buffer_load_dwordx4 v1, s[8:11], s93 offen offset:0 lds
    buffer_load_dwordx4 v2, s[8:11], s93 offen offset:1024 lds
    buffer_load_dwordx4 v3, s[8:11], s93 offen offset:2048 lds
    s_call_b64 s[40:41], F_wait
    v_writelane_b32 v5, 3, 2
    v_writelane_b32 v5, 5, 4
L_fr28:
    v_cmp_lt_u32 vcc, v6, v5
    s_nop 1
    s_cbranch_vccz L_ok28
    ds_read_b32 v6, v7
    s_sub_u32 s46, s46, 1
    s_waitcnt lgkmcnt(0)
    s_cbranch_scc0 L_fr28
    s_mov_b32 s46, 0
L_ok28:
    s_mul_i32 s50, s33, 17
    s_add_u32 s50, s50, s48
    s_mov_b32 m0, 6144
    s_add_u32 s93, s50, 3072
    buffer_load_dwordx4 v1, s[8:11], s50 offen offset:0 lds
    buffer_load_dwordx4 v2, s[8:11], s50 offen offset:1024 lds
    buffer_load_dwordx4 v3, s[8:11], s50 offen offset:2048 lds
    s_call_b64 s[40:41], F_wait
    s_mov_b32 m0, 9216
    s_nop 0
    buffer_load_dwordx4 v1, s[8:11], s93 offen offset:0 lds
    buffer_load_dwordx4 v2, s[8:11], s93 offen offset:1024 lds
    buffer_load_dwordx4 v3, s[8:11], s93 offen offset:2048 lds
    s_call_b64 s[40:41], F_wait
    v_writelane_b32 v5, 3, 9
L_fr29:
    v_cmp_lt_u32 vcc, v6, v5
    s_nop 1
    s_cbranch_vccz L_ok29
    ds_read_b32 v6, v7
    s_sub_u32 s46, s46, 1
    s_waitcnt lgkmcnt(0)
    s_cbranch_scc0 L_fr29
    s_mov_b32 s46, 0
L_ok29:
    s_mul_i32 s50, s33, 16
    s_add_u32 s50, s50, s48
    s_mov_b32 m0, 55296
    s_add_u32 s93, s50, 3072
    buffer_load_dwordx4 v1, s[12:15], s50 offen offset:0 lds
    buffer_load_dwordx4 v2, s[12:15], s50 offen offset:1024 lds
    buffer_load_dwordx4 v3, s[12:15], s50 offen offset:2048 lds
    s_call_b64 s[40:41], F_wait
    s_mov_b32 m0, 58368
    s_nop 0
    buffer_load_dwordx4 v1, s[12:15], s93 offen offset:0 lds
    buffer_load_dwordx4 v2, s[12:15], s93 offen offset:1024 lds
    buffer_load_dwordx4 v3, s[12:15], s93 offen offset:2048 lds
    s_call_b64 s[40:41], F_wait
    v_writelane_b32 v5, 3, 10
    v_writelane_b32 v5, 5, 12
L_fr30:
    v_cmp_lt_u32 vcc, v6, v5
    s_nop 1
    s_cbranch_vccz L_ok30
    ds_read_b32 v6, v7
    s_sub_u32 s46, s46, 1
    s_waitcnt lgkmcnt(0)
    s_cbranch_scc0 L_fr30
    s_mov_b32 s46, 0
L_ok30:
    s_mul_i32 s50, s33, 17
    s_add_u32 s50, s50, s48
    s_mov_b32 m0, 61440
    s_add_u32 s93, s50, 3072
    buffer_load_dwordx4 v1, s[12:15], s50 offen offset:0 lds
    buffer_load_dwordx4 v2, s[12:15], s50 offen offset:1024 lds
    buffer_load_dwordx4 v3, s[12:15], s50 offen offset:2048 lds
    s_call_b64 s[40:41], F_wait
    s_mov_b32 m0, 64512
    s_nop 0
    buffer_load_dwordx4 v1, s[12:15], s93 offen offset:0 lds
    buffer_load_dwordx4 v2, s[12:15], s93 offen offset:1024 lds
    buffer_load_dwordx4 v3, s[12:15], s93 offen offset:2048 lds
    s_call_b64 s[40:41], F_wait
    v_writelane_b32 v5, 3, 28
L_fr31:
    v_cmp_lt_u32 vcc, v6, v5
    s_nop 1
    s_cbranch_vccz L_ok31
    ds_read_b32 v6, v7
    s_sub_u32 s46, s46, 1
    s_waitcnt lgkmcnt(0)
    s_cbranch_scc0 L_fr31
    s_mov_b32 s46, 0
L_ok31:
    s_mul_i32 s50, s33, 12
    s_add_u32 s50, s50, s48
    s_mov_b32 m0, 110592
    s_add_u32 s93, s50, 3072
    buffer_load_dwordx4 v1, s[4:7], s50 offen offset:0 nt lds
    buffer_load_dwordx4 v2, s[4:7], s50 offen offset:1024 nt lds
    buffer_load_dwordx4 v3, s[4:7], s50 offen offset:2048 nt lds
    s_call_b64 s[40:41], F_wait
    s_mov_b32 m0, 113664
    s_nop 0
    buffer_load_dwordx4 v1, s[4:7], s93 offen offset:0 nt lds
    buffer_load_dwordx4 v2, s[4:7], s93 offen offset:1024 nt lds
    buffer_load_dwordx4 v3, s[4:7], s93 offen offset:2048 nt lds
    s_call_b64 s[40:41], F_wait
    v_writelane_b32 v5, 3, 29
L_fr32:
    v_cmp_lt_u32 vcc, v6, v5
    s_nop 1
    s_cbranch_vccz L_ok32
    ds_read_b32 v6, v7
    s_sub_u32 s46, s46, 1
    s_waitcnt lgkmcnt(0)
    s_cbranch_scc0 L_fr32
    s_mov_b32 s46, 0
L_ok32:
    s_mul_i32 s50, s33, 13
    s_add_u32 s50, s50, s48
    s_mov_b32 m0, 116736
    s_add_u32 s93, s50, 3072
    buffer_load_dwordx4 v1, s[4:7], s50 offen offset:0 nt lds
    buffer_load_dwordx4 v2, s[4:7], s50 offen offset:1024 nt lds
    buffer_load_dwordx4 v3, s[4:7], s50 offen offset:2048 nt lds
    s_call_b64 s[40:41], F_wait
    s_mov_b32 m0, 119808
    s_nop 0
    buffer_load_dwordx4 v1, s[4:7], s93 offen offset:0 nt lds
    buffer_load_dwordx4 v2, s[4:7], s93 offen offset:1024 nt lds
    buffer_load_dwordx4 v3, s[4:7], s93 offen offset:2048 nt lds
    s_call_b64 s[40:41], F_wait
    v_writelane_b32 v5, 3, 30
L_fr33:
    v_cmp_lt_u32 vcc, v6, v5
    s_nop 1
    s_cbranch_vccz L_ok33
    ds_read_b32 v6, v7
    s_sub_u32 s46, s46, 1
    s_waitcnt lgkmcnt(0)
    s_cbranch_scc0 L_fr33
    s_mov_b32 s46, 0
L_ok33:
    s_mul_i32 s50, s33, 14
    s_add_u32 s50, s50, s48
    s_mov_b32 m0, 122880
    s_add_u32 s93, s50, 3072
    buffer_load_dwordx4 v1, s[4:7], s50 offen offset:0 nt lds
    buffer_load_dwordx4 v2, s[4:7], s50 offen offset:1024 nt lds
    buffer_load_dwordx4 v3, s[4:7], s50 offen offset:2048 nt lds
    s_call_b64 s[40:41], F_wait
    s_mov_b32 m0, 125952
    s_nop 0
    buffer_load_dwordx4 v1, s[4:7], s93 offen offset:0 nt lds
    buffer_load_dwordx4 v2, s[4:7], s93 offen offset:1024 nt lds
    buffer_load_dwordx4 v3, s[4:7], s93 offen offset:2048 nt lds
    s_call_b64 s[40:41], F_wait
    v_writelane_b32 v5, 3, 31
L_fr34:
    v_cmp_lt_u32 vcc, v6, v5
    s_nop 1
    s_cbranch_vccz L_ok34
    ds_read_b32 v6, v7
    s_sub_u32 s46, s46, 1
    s_waitcnt lgkmcnt(0)
    s_cbranch_scc0 L_fr34
    s_mov_b32 s46, 0
L_ok34:
    s_mul_i32 s50, s33, 15
    s_add_u32 s50, s50, s48
    s_mov_b32 m0, 129024
    s_add_u32 s93, s50, 3072
    buffer_load_dwordx4 v1, s[4:7], s50 offen offset:0 nt lds
    buffer_load_dwordx4 v2, s[4:7], s50 offen offset:1024 nt lds
    buffer_load_dwordx4 v3, s[4:7], s50 offen offset:2048 nt lds
    s_call_b64 s[40:41], F_wait
    s_mov_b32 m0, 132096
    s_nop 0
    buffer_load_dwordx4 v1, s[4:7], s93 offen offset:0 nt lds
    buffer_load_dwordx4 v2, s[4:7], s93 offen offset:1024 nt lds
    buffer_load_dwordx4 v3, s[4:7], s93 offen offset:2048 nt lds
    s_call_b64 s[40:41], F_wait
    s_mov_b64 exec, 1
    v_max_u32 v8, 51, v8
    s_waitcnt vmcnt(30)
    ds_write_b32 v9, v8
    v_max_u32 v8, 52, v8
    s_waitcnt vmcnt(24)
    ds_write_b32 v9, v8
    v_max_u32 v8, 53, v8
    s_waitcnt vmcnt(18)
    ds_write_b32 v9, v8
    v_max_u32 v8, 54, v8
    s_waitcnt vmcnt(12)
    ds_write_b32 v9, v8
    v_max_u32 v8, 55, v8
    s_waitcnt vmcnt(6)
    ds_write_b32 v9, v8
    v_max_u32 v8, 56, v8
    s_waitcnt vmcnt(0)
    ds_write_b32 v9, v8
    s_waitcnt lgkmcnt(0)
    s_endpgm
F_wait:
    s_add_u32 s56, s56, 1
    s_max_i32 s35, s56, 0
    s_lshr_b32 s35, s35, 1
    v_mov_b32 v8, s35
    s_mov_b64 exec, 1
    s_waitcnt vmcnt(33)
F_wait_p:
    ds_write_b32 v9, v8
    s_mov_b64 exec, -1
    s_setpc_b64 s[40:41]
L_cons:
    s_mov_b32 s18, 25165824
    s_mov_b32 s19, 0x20000
    v_and_b32 v53, 15, v0
    v_lshrrev_b32 v54, 4, v0
    v_mul_u32_u24 v55, 384, v53
    v_lshl_add_u32 v4, v54, 4, v55
    s_lshl_b32 s35, s98, 2
    s_lshr_b32 s28, 0x1023040, s35
    s_and_b32 s28, s28, 7
    s_waitcnt lgkmcnt(0)
    s_cmp_lg_u32 s98, 1
    s_cbranch_scc1 L_join
    v_and_b32 v52, 1, v0
    v_mul_u32_u24 v52, 384, v52
    v_lshl_add_u32 v52, v54, 4, v52
    buffer_load_dwordx4 v[84:87], v52, s[4:7], s34 offen offset:0
    buffer_load_dwordx4 v[88:91], v52, s[4:7], s34 offen offset:64
    buffer_load_dwordx4 v[92:95], v52, s[4:7], s34 offen offset:128
    buffer_load_dwordx4 v[96:99], v52, s[4:7], s34 offen offset:192
    buffer_load_dwordx4 v[100:103], v52, s[4:7], s34 offen offset:256
    buffer_load_dwordx4 v[104:107], v52, s[4:7], s34 offen offset:320
L_join:
    s_mov_b32 s42, 0x3dd53b95
    s_mov_b32 s44, 0
    s_lshl_b32 s35, s28, 2
    s_add_u32 s35, s35, 161792
    v_mov_b32 v2, s35
    v_mov_b32 v1, 161856
    v_lshlrev_b32 v52, 4, v53
    v_and_b32 v52, 0x60, v52
    v_xor_b32 v13, v52, v4
    v_xor_b32 v14, 64, v13
    v_lshrrev_b32 v52, 2, v0
    v_mul_u32_u24 v15, 384, v52
    v_lshlrev_b32 v52, 4, v52
    v_and_b32 v52, 0x60, v52
    v_and_b32 v55, 3, v0
    v_lshlrev_b32 v55, 3, v55
    v_add3_u32 v15, v15, v52, v55
    v_add_u32 v15, 55296, v15
    v_xor_b32 v16, 32, v15
    v_xor_b32 v17, 64, v15
    v_xor_b32 v18, 0x60, v15
    v_mov_b32 v56, 0x3f803f80
    v_mov_b32 v57, 0x3f803f80
    v_mov_b32 v58, 0x3f803f80
    v_mov_b32 v59, 0x3f803f80
    s_cmp_eq_u32 s98, 1
    s_cbranch_scc1 L_gmain
    v_and_b32 v52, 1, v54
    v_mul_u32_u24 v52, 384, v52
    v_add_u32 v52, 159744, v52
    v_add_u32 v19, v52, v55
    v_lshrrev_b32 v52, 3, v0
    v_and_b32 v55, 7, v0
    v_mul_u32_u24 v5, 384, v52
    v_lshl_add_u32 v5, v55, 4, v5
    v_xor_b32 v55, v55, v54
    v_lshlrev_b32 v55, 4, v55
    v_lshl_add_u32 v55, v52, 7, v55
    v_add_u32 v11, 135168, v55
    v_xor_b32 v12, 64, v11
    s_cmp_eq_u32 s98, 2
    s_cbranch_scc1 L_storer
    s_setprio 2
    s_mul_i32 s36, s28, s33
    s_add_u32 s32, s48, s36
    s_mul_i32 s49, s28, 6144
    s_lshl_b32 s47, s28, 3
    s_mov_b32 s99, 0
    v_add_u32 v11, s49, v11
    v_add_u32 v12, s49, v12
    s_add_u32 s35, s49, 135168
    v_and_b32 v52, 14, v53
    v_xor_b32 v52, v52, v54
    v_lshlrev_b32 v52, 3, v52
    v_lshl_add_u32 v52, v53, 7, v52
    v_add_u32 v7, s35, v52
    v_xor_b32 v8, 32, v7
    v_xor_b32 v9, 64, v7
    v_xor_b32 v10, 0x60, v7
    v_mul_u32_u24 v6, 384, v53
    v_and_b32 v52, 1, v54
    v_lshl_add_u32 v6, v52, 5, v6
    v_lshrrev_b32 v52, 1, v54
    v_lshl_add_u32 v6, v52, 4, v6
    s_add_u32 s35, s49, 110592
    v_add_u32 v108, s35, v13
    v_add_u32 v109, s35, v14
    s_mov_b32 s90, -1
    s_mov_b32 s91, 0
    v_bfe_u32 v50, v0, 2, 1
    v_mul_u32_u24 v50, 384, v50
    v_lshl_add_u32 v50, v54, 4, v50
    v_add_u32 v50, 160768, v50
    v_lshlrev_b32 v54, 2, v54
    v_sub_u32 v52, v54, v53
    v_cmp_ge_i32 s[66:67], v52, 0
    v_cmp_le_i32 s[74:75], v52, 0
    v_cmp_ge_i32 s[68:69], v52, -1
    v_cmp_le_i32 s[76:77], v52, -1
    v_cmp_ge_i32 s[70:71], v52, -2
    v_cmp_le_i32 s[78:79], v52, -2
    v_cmp_ge_i32 s[72:73], v52, -3
    v_cmp_le_i32 s[80:81], v52, -3
    s_cmp_eq_u32 s31, 1
    s_cselect_b64 s[82:83], s[74:75], s[66:67]
    s_cselect_b64 s[58:59], s[66:67], s[74:75]
    s_cselect_b64 s[84:85], s[76:77], s[68:69]
    s_cselect_b64 s[60:61], s[68:69], s[76:77]
    s_cselect_b64 s[86:87], s[78:79], s[70:71]
    s_cselect_b64 s[62:63], s[70:71], s[78:79]
    s_cselect_b64 s[88:89], s[80:81], s[72:73]
    s_cselect_b64 s[64:65], s[72:73], s[80:81]
    s_cselect_b32 s35, -16, 16
    s_cselect_b32 s36, 240, 0
    s_lshl_b32 s37, s30, 8
    s_add_u32 s36, s36, s37
    s_sub_u32 s37, s28, 2
    s_mul_i32 s37, s37, s35
    s_add_u32 s36, s36, s37
    s_sub_u32 s36, s36, 2
    s_movk_i32 s38, 2046
    v_add_u32 v52, s36, v54
    s_add_u32 s36, s36, s35
    v_cmp_gt_u32 s[50:51], s38, v52
    v_add_u32 v52, 1, v52
    v_cmp_gt_u32 s[52:53], s38, v52
    v_add_u32 v52, 1, v52
    v_cmp_gt_u32 s[54:55], s38, v52
    v_add_u32 v52, 1, v52
    v_cmp_gt_u32 s[56:57], s38, v52
    v_add_u32 v52, s36, v54
    s_add_u32 s36, s36, s35
    v_cmp_gt_u32 s[66:67], s38, v52
    v_add_u32 v52, 1, v52
    v_cmp_gt_u32 s[68:69], s38, v52
    v_add_u32 v52, 1, v52
    v_cmp_gt_u32 s[70:71], s38, v52
    v_add_u32 v52, 1, v52
    v_cmp_gt_u32 s[72:73], s38, v52
    v_add_u32 v52, s36, v54
    v_cmp_gt_u32 s[74:75], s38, v52
    v_add_u32 v52, 1, v52
    v_cmp_gt_u32 s[76:77], s38, v52
    v_add_u32 v52, 1, v52
    v_cmp_gt_u32 s[78:79], s38, v52
    v_add_u32 v52, 1, v52
    v_cmp_gt_u32 s[80:81], s38, v52
    s_and_b64 s[50:51], s[50:51], s[82:83]
    s_and_b64 s[52:53], s[52:53], s[84:85]
    s_and_b64 s[54:55], s[54:55], s[86:87]
    s_and_b64 s[56:57], s[56:57], s[88:89]
    s_mov_b32 s92, s49
    s_mul_i32 s43, s33, 12
    s_add_u32 s43, s43, s32
    s_call_b64 s[40:41], F_addr
    s_movk_i32 s45, 1
    s_call_b64 s[40:41], F_poll
    ds_read_b128 v[60:63], v50 offset:0
    ds_read_b128 v[64:67], v50 offset:64
    ds_read_b128 v[68:71], v50 offset:128
    ds_read_b128 v[72:75], v50 offset:192
    ds_read_b128 v[76:79], v50 offset:256
    ds_read_b128 v[80:83], v50 offset:320
    s_waitcnt lgkmcnt(0)
    v_mov_b32 v3, 1
    s_lshr_b32 s94, 0x120f0806, s47
    s_and_b32 s94, s94, 0xff
    s_lshr_b32 s95, 0x1613100d, s47
    s_and_b32 s95, s95, 0xff
    s_lshr_b32 s45, 0x110e0c0b, s47
    s_and_b32 s45, s45, 0xff
    s_call_b64 s[40:41], F_poll
    s_call_b64 s[40:41], F_a
    s_mov_b64 s[50:51], s[82:83]
    s_mov_b64 s[66:67], -1
    s_mov_b64 s[74:75], -1
    s_mov_b64 s[52:53], s[84:85]
    s_mov_b64 s[68:69], -1
    s_mov_b64 s[76:77], -1
    s_mov_b64 s[54:55], s[86:87]
    s_mov_b64 s[70:71], -1
    s_mov_b64 s[78:79], -1
    s_mov_b64 s[56:57], s[88:89]
    s_mov_b64 s[72:73], -1
    s_mov_b64 s[80:81], -1
    s_add_u32 s92, s92, 24576
    s_sub_u32 s36, s92, 55296
    s_cselect_b32 s92, s92, s36
    s_call_b64 s[40:41], F_addr
    v_mov_b32 v3, 2
    s_movk_i32 s45, 1
    s_call_b64 s[40:41], F_pollo
    s_lshr_b32 s94, 0x1e1b1815, s47
    s_and_b32 s94, s94, 0xff
    s_lshr_b32 s95, 0x221f1c19, s47
    s_and_b32 s95, s95, 0xff
    s_lshr_b32 s45, 0x1d1a1714, s47
    s_and_b32 s45, s45, 0xff
    s_call_b64 s[40:41], F_poll
    s_call_b64 s[40:41], F_a
    s_add_u32 s92, s92, 24576
    s_sub_u32 s36, s92, 55296
    s_cselect_b32 s92, s92, s36
    s_call_b64 s[40:41], F_addr
    v_mov_b32 v3, 3
    s_movk_i32 s45, 2
    s_call_b64 s[40:41], F_pollo
    s_lshr_b32 s94, 0x29272421, s47
    s_and_b32 s94, s94, 0xff
    s_lshr_b32 s95, 0x2b2a2625, s47
    s_and_b32 s95, s95, 0xff
    s_lshr_b32 s45, 0x2c282320, s47
    s_and_b32 s45, s45, 0xff
    s_call_b64 s[40:41], F_poll
    s_call_b64 s[40:41], F_a
    s_add_u32 s92, s92, 24576
    s_sub_u32 s36, s92, 55296
    s_cselect_b32 s92, s92, s36
    s_call_b64 s[40:41], F_addr
L_last:
    s_cmp_ge_u32 s28, 2
    s_cbranch_scc0 L_lp
    s_setprio 3
L_lp:
    s_movk_i32 s45, 3
    s_call_b64 s[40:41], F_pollo
    s_lshr_b32 s45, 0x3433302f, s47
    s_and_b32 s45, s45, 0xff
    s_call_b64 s[40:41], F_poll
    ds_read_b128 v[168:171], v20 offset:0
    ds_read_b128 v[172:175], v21 offset:0
    ds_read_b128 v[176:179], v20 offset:128
    ds_read_b128 v[180:183], v21 offset:128
    ds_read_b128 v[184:187], v20 offset:256
    ds_read_b128 v[188:191], v21 offset:256
    ds_read_b128 v[192:195], v22 offset:0
    ds_read_b128 v[196:199], v23 offset:0
    ds_read_b128 v[200:203], v22 offset:128
    ds_read_b128 v[204:207], v23 offset:128
    ds_read_b128 v[208:211], v22 offset:256
    ds_read_b128 v[212:215], v23 offset:256
    s_lshr_b32 s45, 0x38373635, s47
    s_and_b32 s45, s45, 0xff
    s_waitcnt lgkmcnt(0)
    s_call_b64 s[40:41], F_poll
    s_call_b64 s[40:41], F_last
L_end:
    s_endpgm
F_poll:
    s_cmp_ge_u32 s44, s45
    s_cbranch_scc1 F_poll_ok
    ds_read_b32 v253, v1
    s_sub_u32 s46, s46, 1
    s_waitcnt lgkmcnt(0)
    v_readfirstlane_b32 s44, v253
    s_nop 0
    s_cbranch_scc0 F_poll
    s_mov_b32 s46, 0
F_poll_ok:
    s_setpc_b64 s[40:41]
F_pollo:
    ds_read_b32 v253, v2 offset:96
    s_sub_u32 s46, s46, 1
    s_cbranch_scc1 F_pollo_x
    s_waitcnt lgkmcnt(0)
    v_readfirstlane_b32 s35, v253
    s_nop 1
    s_cmp_ge_u32 s35, s45
    s_cbranch_scc0 F_pollo
    s_setpc_b64 s[40:41]
F_pollo_x:
    s_mov_b32 s46, 0
    s_waitcnt lgkmcnt(0)
    s_setpc_b64 s[40:41]
F_addr:
    s_add_u32 s35, s92, 0
    s_sub_u32 s36, s35, 55296
    s_cselect_b32 s35, s35, s36
    v_add_u32 v20, s35, v13
    v_add_u32 v21, s35, v14
    v_add_u32 v30, s35, v15
    v_add_u32 v31, s35, v16
    v_add_u32 v32, s35, v17
    v_add_u32 v33, s35, v18
    s_add_u32 s35, s92, 6144
    s_sub_u32 s36, s35, 55296
    s_cselect_b32 s35, s35, s36
    v_add_u32 v22, s35, v13
    v_add_u32 v23, s35, v14
    v_add_u32 v34, s35, v15
    v_add_u32 v35, s35, v16
    v_add_u32 v36, s35, v17
    v_add_u32 v37, s35, v18
    s_add_u32 s35, s92, 12288
    s_sub_u32 s36, s35, 55296
    s_cselect_b32 s35, s35, s36
    v_add_u32 v24, s35, v13
    v_add_u32 v25, s35, v14
    v_add_u32 v38, s35, v15
    v_add_u32 v39, s35, v16
    v_add_u32 v40, s35, v17
    v_add_u32 v41, s35, v18
    s_add_u32 s35, s92, 18432
    s_sub_u32 s36, s35, 55296
    s_cselect_b32 s35, s35, s36
    v_add_u32 v26, s35, v13
    v_add_u32 v27, s35, v14
    v_add_u32 v42, s35, v15
    v_add_u32 v43, s35, v16
    v_add_u32 v44, s35, v17
    v_add_u32 v45, s35, v18
    s_add_u32 s35, s92, 24576
    s_sub_u32 s36, s35, 55296
    s_cselect_b32 s35, s35, s36
    v_add_u32 v28, s35, v13
    v_add_u32 v29, s35, v14
    v_add_u32 v46, s35, v15
    v_add_u32 v47, s35, v16
    v_add_u32 v48, s35, v17
    v_add_u32 v49, s35, v18
    s_setpc_b64 s[40:41]
F_a:
    ds_read_b128 v[84:87], v108 offset:0
    ds_read_b128 v[88:91], v109 offset:0
    ds_read_b128 v[92:95], v108 offset:128
    ds_read_b128 v[96:99], v109 offset:128
    ds_read_b128 v[100:103], v108 offset:256
    ds_read_b128 v[104:107], v109 offset:256
    s_mov_b64 exec, 1
    ds_write_b32 v2, v3 offset:112
    s_mov_b64 exec, -1
    ds_read_b128 v[168:171], v20 offset:0
    ds_read_b128 v[172:175], v21 offset:0
    ds_read_b128 v[176:179], v20 offset:128
    ds_read_b128 v[180:183], v21 offset:128
    ds_read_b128 v[184:187], v20 offset:256
    ds_read_b128 v[188:191], v21 offset:256
    v_mov_b32 v53, 0xff800000
    v_mov_b32 v159, 0
    s_waitcnt lgkmcnt(12)
    v_mfma_f32_16x16x32_bf16 v[152:155], v[60:63], v[84:87], 0
    ds_read_b128 v[192:195], v22 offset:0
    s_waitcnt lgkmcnt(12)
    v_mfma_f32_16x16x32_bf16 v[152:155], v[64:67], v[88:91], v[152:155]
    ds_read_b128 v[196:199], v23 offset:0
    s_waitcnt lgkmcnt(12)
    v_mfma_f32_16x16x32_bf16 v[152:155], v[68:71], v[92:95], v[152:155]
    ds_read_b128 v[200:203], v22 offset:128
    s_waitcnt lgkmcnt(12)
    v_mfma_f32_16x16x32_bf16 v[152:155], v[72:75], v[96:99], v[152:155]
    ds_read_b128 v[204:207], v23 offset:128
    s_waitcnt lgkmcnt(12)
    v_mfma_f32_16x16x32_bf16 v[152:155], v[76:79], v[100:103], v[152:155]
    ds_read_b128 v[208:211], v22 offset:256
    s_waitcnt lgkmcnt(12)
    v_mfma_f32_16x16x32_bf16 v[152:155], v[80:83], v[104:107], v[152:155]
    ds_read_b128 v[212:215], v23 offset:256
    s_waitcnt lgkmcnt(10)
    v_mfma_f32_16x16x32_bf16 v[132:135], v[168:171], v[84:87], 0
    ds_read_b128 v[168:171], v24 offset:0
    v_mfma_f32_16x16x32_bf16 v[132:135], v[172:175], v[88:91], v[132:135]
    ds_read_b128 v[172:175], v25 offset:0
    s_waitcnt lgkmcnt(10)
    v_mfma_f32_16x16x32_bf16 v[132:135], v[176:179], v[92:95], v[132:135]
    ds_read_b128 v[176:179], v24 offset:128
    v_mfma_f32_16x16x32_bf16 v[132:135], v[180:183], v[96:99], v[132:135]
    ds_read_b128 v[180:183], v25 offset:128
    s_waitcnt lgkmcnt(10)
    v_mfma_f32_16x16x32_bf16 v[132:135], v[184:187], v[100:103], v[132:135]
    ds_read_b128 v[184:187], v24 offset:256
    v_mfma_f32_16x16x32_bf16 v[132:135], v[188:191], v[104:107], v[132:135]
    ds_read_b128 v[188:191], v25 offset:256
    s_waitcnt lgkmcnt(10)
    v_mfma_f32_16x16x32_bf16 v[136:139], v[192:195], v[84:87], 0
    ds_read_b128 v[192:195], v26 offset:0
    v_mfma_f32_16x16x32_bf16 v[136:139], v[196:199], v[88:91], v[136:139]
    ds_read_b128 v[196:199], v27 offset:0
    s_waitcnt lgkmcnt(10)
    v_mfma_f32_16x16x32_bf16 v[136:139], v[200:203], v[92:95], v[136:139]
    ds_read_b128 v[200:203], v26 offset:128
    v_mfma_f32_16x16x32_bf16 v[136:139], v[204:207], v[96:99], v[136:139]
    ds_read_b128 v[204:207], v27 offset:128
    s_waitcnt lgkmcnt(10)
    v_mfma_f32_16x16x32_bf16 v[136:139], v[208:211], v[100:103], v[136:139]
    ds_read_b128 v[208:211], v26 offset:256
    v_mfma_f32_16x16x32_bf16 v[136:139], v[212:215], v[104:107], v[136:139]
    ds_read_b128 v[212:215], v27 offset:256
    ds_read_b32 v253, v1
    s_waitcnt lgkmcnt(11)
    v_mfma_f32_16x16x32_bf16 v[140:143], v[168:171], v[84:87], 0
    v_cndmask_b32 v50, v53, v152, s[90:91]
    v_cndmask_b32 v132, v53, v132, s[50:51]
    v_mfma_f32_16x16x32_bf16 v[140:143], v[172:175], v[88:91], v[140:143]
    v_cndmask_b32 v133, v53, v133, s[52:53]
    v_cndmask_b32 v134, v53, v134, s[54:55]
    s_waitcnt lgkmcnt(9)
    v_mfma_f32_16x16x32_bf16 v[140:143], v[176:179], v[92:95], v[140:143]
    v_cndmask_b32 v135, v53, v135, s[56:57]
    v_mov_b32 v152, v50
    v_mfma_f32_16x16x32_bf16 v[140:143], v[180:183], v[96:99], v[140:143]
    v_max3_f32 v50, v50, v132, v133
    v_max3_f32 v50, v50, v134, v135
    s_waitcnt lgkmcnt(7)
    v_mfma_f32_16x16x32_bf16 v[140:143], v[184:187], v[100:103], v[140:143]
    v_mfma_f32_16x16x32_bf16 v[140:143], v[188:191], v[104:107], v[140:143]
    s_waitcnt lgkmcnt(0)
    v_readfirstlane_b32 s44, v253
    s_nop 1
    s_cmp_ge_u32 s44, s94
    s_cbranch_scc1 L_ck47
L_lp47:
    ds_read_b32 v253, v1
    s_sub_u32 s46, s46, 1
    s_cbranch_scc1 L_ex47
    s_waitcnt lgkmcnt(0)
    v_readfirstlane_b32 s44, v253
    s_nop 1
    s_cmp_ge_u32 s44, s94
    s_cbranch_scc0 L_lp47
    s_branch L_ck47
L_ex47:
    s_mov_b32 s46, 0
    s_waitcnt lgkmcnt(0)
L_ck47:
    ds_read_b128 v[168:171], v28 offset:0
    ds_read_b128 v[172:175], v29 offset:0
    ds_read_b128 v[176:179], v28 offset:128
    ds_read_b128 v[180:183], v29 offset:128
    ds_read_b128 v[184:187], v28 offset:256
    ds_read_b128 v[188:191], v29 offset:256
    s_mov_b64 exec, 1
    ds_write_b32 v2, v3 offset:0
    s_mov_b64 exec, -1
    v_mfma_f32_16x16x32_bf16 v[144:147], v[192:195], v[84:87], 0
    v_cndmask_b32 v136, v53, v136, s[66:67]
    v_cndmask_b32 v137, v53, v137, s[68:69]
    v_mfma_f32_16x16x32_bf16 v[144:147], v[196:199], v[88:91], v[144:147]
    v_cndmask_b32 v138, v53, v138, s[70:71]
    v_cndmask_b32 v139, v53, v139, s[72:73]
    v_mfma_f32_16x16x32_bf16 v[144:147], v[200:203], v[92:95], v[144:147]
    v_max3_f32 v50, v50, v136, v137
    v_max3_f32 v50, v50, v138, v139
    v_mfma_f32_16x16x32_bf16 v[144:147], v[204:207], v[96:99], v[144:147]
    v_mfma_f32_16x16x32_bf16 v[144:147], v[208:211], v[100:103], v[144:147]
    v_mfma_f32_16x16x32_bf16 v[144:147], v[212:215], v[104:107], v[144:147]
    s_waitcnt lgkmcnt(5)
    v_mfma_f32_16x16x32_bf16 v[148:151], v[168:171], v[84:87], 0
    v_cndmask_b32 v140, v53, v140, s[74:75]
    v_cndmask_b32 v141, v53, v141, s[76:77]
    v_mfma_f32_16x16x32_bf16 v[148:151], v[172:175], v[88:91], v[148:151]
    v_cndmask_b32 v142, v53, v142, s[78:79]
    v_cndmask_b32 v143, v53, v143, s[80:81]
    s_waitcnt lgkmcnt(3)
    v_mfma_f32_16x16x32_bf16 v[148:151], v[176:179], v[92:95], v[148:151]
    v_max3_f32 v50, v50, v140, v141
    v_max3_f32 v50, v50, v142, v143
    v_mfma_f32_16x16x32_bf16 v[148:151], v[180:183], v[96:99], v[148:151]
    v_max3_f32 v50, v50, v144, v145
    v_max3_f32 v50, v50, v146, v147
    s_waitcnt lgkmcnt(1)
    v_mfma_f32_16x16x32_bf16 v[148:151], v[184:187], v[100:103], v[148:151]
    v_mfma_f32_16x16x32_bf16 v[148:151], v[188:191], v[104:107], v[148:151]
    ds_read_b64_tr_b16 v[220:221], v30 offset:0
    ds_read_b64_tr_b16 v[222:223], v19 offset:0
    ds_read_b64_tr_b16 v[224:225], v31 offset:0
    ds_read_b64_tr_b16 v[226:227], v19 offset:32
    ds_read_b64_tr_b16 v[228:229], v32 offset:0
    ds_read_b64_tr_b16 v[230:231], v19 offset:64
    ds_read_b64_tr_b16 v[232:233], v33 offset:0
    ds_read_b64_tr_b16 v[234:235], v19 offset:96
    v_cndmask_b32 v148, v53, v148, s[58:59]
    v_cndmask_b32 v149, v53, v149, s[60:61]
    v_cndmask_b32 v150, v53, v150, s[62:63]
    v_cndmask_b32 v151, v53, v151, s[64:65]
    v_max3_f32 v50, v50, v148, v149
    v_max3_f32 v50, v50, v150, v151
    v_mov_b32 v51, v50
    ds_read_b64_tr_b16 v[236:237], v30 offset:128
    ds_read_b64_tr_b16 v[238:239], v19 offset:128
    v_permlane32_swap_b32 v50, v51
    v_max_f32 v50, v50, v51
    v_mov_b32 v51, v50
    ds_read_b64_tr_b16 v[240:241], v31 offset:128
    ds_read_b64_tr_b16 v[242:243], v19 offset:160
    v_permlane16_swap_b32 v50, v51
    v_max_f32 v50, v50, v51
    v_mul_f32 v51, s42, v50
    ds_read_b64_tr_b16 v[244:245], v32 offset:128
    ds_read_b64_tr_b16 v[246:247], v19 offset:192
    v_fma_f32 v132, v132, s42, -v51
    v_fma_f32 v133, v133, s42, -v51
    v_fma_f32 v134, v134, s42, -v51
    v_fma_f32 v135, v135, s42, -v51
    v_fma_f32 v152, v152, s42, -v51
    v_exp_f32 v132, v132
    v_exp_f32 v133, v133
    v_exp_f32 v134, v134
    v_exp_f32 v135, v135
    v_exp_f32 v152, v152
    v_cvt_pk_bf16_f32 v156, v132, v133
    v_cvt_pk_bf16_f32 v157, v134, v135
    v_cvt_pk_bf16_f32 v158, v152, 0
    v_fma_f32 v136, v136, s42, -v51
    v_fma_f32 v137, v137, s42, -v51
    v_mfma_f32_16x16x32_bf16 v[216:219], v[56:59], v[156:159], 0
    s_waitcnt lgkmcnt(10)
    v_mfma_f32_16x16x32_bf16 v[168:171], v[220:223], v[156:159], 0
    ds_read_b64_tr_b16 v[248:249], v33 offset:128
    ds_read_b64_tr_b16 v[250:251], v19 offset:224
    v_fma_f32 v138, v138, s42, -v51
    v_fma_f32 v139, v139, s42, -v51
    v_exp_f32 v136, v136
    v_mfma_f32_16x16x32_bf16 v[172:175], v[224:227], v[156:159], 0
    ds_read_b64_tr_b16 v[220:221], v30 offset:256
    ds_read_b64_tr_b16 v[222:223], v19 offset:256
    v_exp_f32 v137, v137
    v_exp_f32 v138, v138
    v_exp_f32 v139, v139
    s_waitcnt lgkmcnt(10)
    v_mfma_f32_16x16x32_bf16 v[176:179], v[228:231], v[156:159], 0
    ds_read_b64_tr_b16 v[224:225], v31 offset:256
    ds_read_b64_tr_b16 v[226:227], v19 offset:288
    v_fma_f32 v140, v140, s42, -v51
    v_fma_f32 v141, v141, s42, -v51
    v_fma_f32 v142, v142, s42, -v51
    v_mfma_f32_16x16x32_bf16 v[180:183], v[232:235], v[156:159], 0
    ds_read_b64_tr_b16 v[228:229], v32 offset:256
    ds_read_b64_tr_b16 v[230:231], v19 offset:320
    v_fma_f32 v143, v143, s42, -v51
    v_exp_f32 v140, v140
    v_exp_f32 v141, v141
    s_waitcnt lgkmcnt(10)
    v_mfma_f32_16x16x32_bf16 v[184:187], v[236:239], v[156:159], 0
    ds_read_b64_tr_b16 v[232:233], v33 offset:256
    ds_read_b64_tr_b16 v[234:235], v19 offset:352
    v_exp_f32 v142, v142
    v_exp_f32 v143, v143
    v_cvt_pk_bf16_f32 v160, v136, v137
    v_mfma_f32_16x16x32_bf16 v[188:191], v[240:243], v[156:159], 0
    ds_read_b64_tr_b16 v[236:237], v34 offset:0
    ds_read_b64_tr_b16 v[238:239], v38 offset:0
    v_cvt_pk_bf16_f32 v161, v138, v139
    v_fma_f32 v144, v144, s42, -v51
    v_fma_f32 v145, v145, s42, -v51
    s_waitcnt lgkmcnt(10)
    v_mfma_f32_16x16x32_bf16 v[192:195], v[244:247], v[156:159], 0
    ds_read_b64_tr_b16 v[240:241], v35 offset:0
    ds_read_b64_tr_b16 v[242:243], v39 offset:0
    v_fma_f32 v146, v146, s42, -v51
    v_fma_f32 v147, v147, s42, -v51
    v_exp_f32 v144, v144
    v_mfma_f32_16x16x32_bf16 v[196:199], v[248:251], v[156:159], 0
    ds_read_b64_tr_b16 v[244:245], v36 offset:0
    ds_read_b64_tr_b16 v[246:247], v40 offset:0
    v_exp_f32 v145, v145
    v_exp_f32 v146, v146
    v_exp_f32 v147, v147
    s_waitcnt lgkmcnt(10)
    v_mfma_f32_16x16x32_bf16 v[200:203], v[220:223], v[156:159], 0
    ds_read_b64_tr_b16 v[248:249], v37 offset:0
    ds_read_b64_tr_b16 v[250:251], v41 offset:0
    v_cvt_pk_bf16_f32 v162, v140, v141
    v_cvt_pk_bf16_f32 v163, v142, v143
    v_fma_f32 v148, v148, s42, -v51
    v_mfma_f32_16x16x32_bf16 v[204:207], v[224:227], v[156:159], 0
    ds_read_b64_tr_b16 v[220:221], v34 offset:128
    ds_read_b64_tr_b16 v[222:223], v38 offset:128
    v_fma_f32 v149, v149, s42, -v51
    v_fma_f32 v150, v150, s42, -v51
    v_fma_f32 v151, v151, s42, -v51
    s_waitcnt lgkmcnt(10)
    v_mfma_f32_16x16x32_bf16 v[208:211], v[228:231], v[156:159], 0
    ds_read_b64_tr_b16 v[224:225], v35 offset:128
    ds_read_b64_tr_b16 v[226:227], v39 offset:128
    v_exp_f32 v148, v148
    v_exp_f32 v149, v149
    v_exp_f32 v150, v150
    v_mfma_f32_16x16x32_bf16 v[212:215], v[232:235], v[156:159], 0
    ds_read_b64_tr_b16 v[228:229], v36 offset:128
    ds_read_b64_tr_b16 v[230:231], v40 offset:128
    s_waitcnt lgkmcnt(10)
    v_mfma_f32_16x16x32_bf16 v[168:171], v[236:239], v[160:163], v[168:171]
    ds_read_b32 v253, v1
    ds_read_b64_tr_b16 v[232:233], v37 offset:128
    ds_read_b64_tr_b16 v[234:235], v41 offset:128
    v_exp_f32 v151, v151
    v_cvt_pk_bf16_f32 v164, v144, v145
    v_cvt_pk_bf16_f32 v165, v146, v147
    v_mfma_f32_16x16x32_bf16 v[172:175], v[240:243], v[160:163], v[172:175]
    ds_read_b64_tr_b16 v[236:237], v34 offset:256
    ds_read_b64_tr_b16 v[238:239], v38 offset:256
    v_cvt_pk_bf16_f32 v166, v148, v149
    v_cvt_pk_bf16_f32 v167, v150, v151
    v_mfma_f32_16x16x32_bf16 v[216:219], v[56:59], v[160:163], v[216:219]
    s_waitcnt lgkmcnt(11)
    v_mfma_f32_16x16x32_bf16 v[176:179], v[244:247], v[160:163], v[176:179]
    ds_read_b64_tr_b16 v[240:241], v35 offset:256
    ds_read_b64_tr_b16 v[242:243], v39 offset:256
    v_mfma_f32_16x16x32_bf16 v[180:183], v[248:251], v[160:163], v[180:183]
    ds_read_b64_tr_b16 v[244:245], v36 offset:256
    ds_read_b64_tr_b16 v[246:247], v40 offset:256
    s_waitcnt lgkmcnt(11)
    v_mfma_f32_16x16x32_bf16 v[184:187], v[220:223], v[160:163], v[184:187]
    ds_read_b64_tr_b16 v[248:249], v37 offset:256
    ds_read_b64_tr_b16 v[250:251], v41 offset:256
    v_mfma_f32_16x16x32_bf16 v[216:219], v[56:59], v[164:167], v[216:219]
    v_mfma_f32_16x16x32_bf16 v[188:191], v[224:227], v[160:163], v[188:191]
    s_waitcnt lgkmcnt(10)
    v_readfirstlane_b32 s44, v253
    s_nop 1
    s_cmp_ge_u32 s44, s95
    s_cbranch_scc1 L_ck48
L_lp48:
    ds_read_b32 v253, v1
    s_sub_u32 s46, s46, 1
    s_cbranch_scc1 L_ex48
    s_waitcnt lgkmcnt(0)
    v_readfirstlane_b32 s44, v253
    s_nop 1
    s_cmp_ge_u32 s44, s95
    s_cbranch_scc0 L_lp48
    s_branch L_ck48
L_ex48:
    s_mov_b32 s46, 0
    s_waitcnt lgkmcnt(0)
L_ck48:
    s_cmp_eq_u32 s99, 1
    ds_read_b64_tr_b16 v[220:221], v42 offset:0
    ds_read_b64_tr_b16 v[222:223], v46 offset:0
    v_mfma_f32_16x16x32_bf16 v[192:195], v[228:231], v[160:163], v[192:195]
    ds_read_b64_tr_b16 v[224:225], v43 offset:0
    ds_read_b64_tr_b16 v[226:227], v47 offset:0
    s_waitcnt lgkmcnt(10)
    v_mfma_f32_16x16x32_bf16 v[196:199], v[232:235], v[160:163], v[196:199]
    ds_read_b64_tr_b16 v[228:229], v44 offset:0
    ds_read_b64_tr_b16 v[230:231], v48 offset:0
    v_mfma_f32_16x16x32_bf16 v[200:203], v[236:239], v[160:163], v[200:203]
    ds_read_b64_tr_b16 v[232:233], v45 offset:0
    ds_read_b64_tr_b16 v[234:235], v49 offset:0
    s_waitcnt lgkmcnt(10)
    v_mfma_f32_16x16x32_bf16 v[204:207], v[240:243], v[160:163], v[204:207]
    ds_read_b64_tr_b16 v[236:237], v42 offset:128
    ds_read_b64_tr_b16 v[238:239], v46 offset:128
    v_rcp_f32 v50, v216
    v_mfma_f32_16x16x32_bf16 v[208:211], v[244:247], v[160:163], v[208:211]
    ds_read_b64_tr_b16 v[240:241], v43 offset:128
    ds_read_b64_tr_b16 v[242:243], v47 offset:128
    s_waitcnt lgkmcnt(10)
    v_mfma_f32_16x16x32_bf16 v[212:215], v[248:251], v[160:163], v[212:215]
    ds_read_b64_tr_b16 v[244:245], v44 offset:128
    ds_read_b64_tr_b16 v[246:247], v48 offset:128
    v_mfma_f32_16x16x32_bf16 v[168:171], v[220:223], v[164:167], v[168:171]
    ds_read_b64_tr_b16 v[248:249], v45 offset:128
    ds_read_b64_tr_b16 v[250:251], v49 offset:128
    s_waitcnt lgkmcnt(12)
    v_mfma_f32_16x16x32_bf16 v[172:175], v[224:227], v[164:167], v[172:175]
    ds_read_b64_tr_b16 v[220:221], v42 offset:256
    ds_read_b64_tr_b16 v[222:223], v46 offset:256
    s_waitcnt lgkmcnt(12)
    v_mfma_f32_16x16x32_bf16 v[176:179], v[228:231], v[164:167], v[176:179]
    ds_read_b64_tr_b16 v[224:225], v43 offset:256
    ds_read_b64_tr_b16 v[226:227], v47 offset:256
    s_waitcnt lgkmcnt(12)
    v_mfma_f32_16x16x32_bf16 v[180:183], v[232:235], v[164:167], v[180:183]
    ds_read_b64_tr_b16 v[228:229], v44 offset:256
    ds_read_b64_tr_b16 v[230:231], v48 offset:256
    v_mul_f32 v168, v50, v168
    v_mul_f32 v169, v50, v169
    v_mul_f32 v170, v50, v170
    v_mul_f32 v171, v50, v171
    v_cvt_pk_bf16_f32 v168, v168, v169
    v_cvt_pk_bf16_f32 v169, v170, v171
    ds_write_b64 v7, v[168:169] offset:0
    s_waitcnt lgkmcnt(13)
    v_mfma_f32_16x16x32_bf16 v[184:187], v[236:239], v[164:167], v[184:187]
    ds_read_b64_tr_b16 v[232:233], v45 offset:256
    ds_read_b64_tr_b16 v[234:235], v49 offset:256
    s_mov_b64 exec, 1
    s_waitcnt lgkmcnt(14)
    ds_write_b32 v2, v3 offset:32
    s_mov_b64 exec, -1
    v_mul_f32 v172, v50, v172
    v_mul_f32 v173, v50, v173
    v_mul_f32 v174, v50, v174
    v_mul_f32 v175, v50, v175
    v_cvt_pk_bf16_f32 v172, v172, v173
    v_cvt_pk_bf16_f32 v173, v174, v175
    s_waitcnt lgkmcnt(14)
    ds_write_b64 v8, v[172:173] offset:0
    v_mfma_f32_16x16x32_bf16 v[188:191], v[240:243], v[164:167], v[188:191]
    v_mul_f32 v176, v50, v176
    v_mul_f32 v177, v50, v177
    v_mul_f32 v178, v50, v178
    v_mul_f32 v179, v50, v179
    v_cvt_pk_bf16_f32 v176, v176, v177
    v_cvt_pk_bf16_f32 v177, v178, v179
    s_waitcnt lgkmcnt(14)
    ds_write_b64 v9, v[176:177] offset:0
    s_waitcnt lgkmcnt(14)
    v_mfma_f32_16x16x32_bf16 v[192:195], v[244:247], v[164:167], v[192:195]
    v_mul_f32 v180, v50, v180
    v_mul_f32 v181, v50, v181
    v_mul_f32 v182, v50, v182
    v_mul_f32 v183, v50, v183
    v_cvt_pk_bf16_f32 v180, v180, v181
    v_cvt_pk_bf16_f32 v181, v182, v183
    ds_write_b64 v10, v[180:181] offset:0
    s_waitcnt lgkmcnt(13)
    v_mfma_f32_16x16x32_bf16 v[196:199], v[248:251], v[164:167], v[196:199]
    v_mul_f32 v184, v50, v184
    v_mul_f32 v185, v50, v185
    v_mul_f32 v186, v50, v186
    v_mul_f32 v187, v50, v187
    v_cvt_pk_bf16_f32 v184, v184, v185
    v_cvt_pk_bf16_f32 v185, v186, v187
    ds_write_b64 v7, v[184:185] offset:2048
    s_waitcnt lgkmcnt(12)
    v_mfma_f32_16x16x32_bf16 v[200:203], v[220:223], v[164:167], v[200:203]
    v_mul_f32 v188, v50, v188
    v_mul_f32 v189, v50, v189
    v_mul_f32 v190, v50, v190
    v_mul_f32 v191, v50, v191
    v_cvt_pk_bf16_f32 v188, v188, v189
    v_cvt_pk_bf16_f32 v189, v190, v191
    ds_write_b64 v8, v[188:189] offset:2048
    s_waitcnt lgkmcnt(11)
    v_mfma_f32_16x16x32_bf16 v[204:207], v[224:227], v[164:167], v[204:207]
    v_mul_f32 v192, v50, v192
    v_mul_f32 v193, v50, v193
    v_mul_f32 v194, v50, v194
    v_mul_f32 v195, v50, v195
    v_cvt_pk_bf16_f32 v192, v192, v193
    v_cvt_pk_bf16_f32 v193, v194, v195
    ds_write_b64 v9, v[192:193] offset:2048
    s_waitcnt lgkmcnt(10)
    v_mfma_f32_16x16x32_bf16 v[208:211], v[228:231], v[164:167], v[208:211]
    v_mul_f32 v196, v50, v196
    v_mul_f32 v197, v50, v197
    v_mul_f32 v198, v50, v198
    v_mul_f32 v199, v50, v199
    v_cvt_pk_bf16_f32 v196, v196, v197
    v_cvt_pk_bf16_f32 v197, v198, v199
    ds_write_b64 v10, v[196:197] offset:2048
    s_waitcnt lgkmcnt(8)
    v_mfma_f32_16x16x32_bf16 v[212:215], v[232:235], v[164:167], v[212:215]
    v_mul_f32 v200, v50, v200
    v_mul_f32 v201, v50, v201
    v_mul_f32 v202, v50, v202
    v_mul_f32 v203, v50, v203
    v_cvt_pk_bf16_f32 v200, v200, v201
    v_cvt_pk_bf16_f32 v201, v202, v203
    ds_write_b64 v7, v[200:201] offset:4096
    v_mul_f32 v204, v50, v204
    v_mul_f32 v205, v50, v205
    v_mul_f32 v206, v50, v206
    v_mul_f32 v207, v50, v207
    v_cvt_pk_bf16_f32 v204, v204, v205
    v_cvt_pk_bf16_f32 v205, v206, v207
    ds_write_b64 v8, v[204:205] offset:4096
    v_mul_f32 v208, v50, v208
    v_mul_f32 v209, v50, v209
    v_mul_f32 v210, v50, v210
    v_mul_f32 v211, v50, v211
    v_cvt_pk_bf16_f32 v208, v208, v209
    v_cvt_pk_bf16_f32 v209, v210, v211
    ds_write_b64 v9, v[208:209] offset:4096
    v_mul_f32 v212, v50, v212
    v_mul_f32 v213, v50, v213
    v_mul_f32 v214, v50, v214
    v_mul_f32 v215, v50, v215
    v_cvt_pk_bf16_f32 v212, v212, v213
    v_cvt_pk_bf16_f32 v213, v214, v215
    ds_write_b64 v10, v[212:213] offset:4096
    s_mov_b64 exec, 1
    ds_write_b32 v2, v3 offset:80
    s_mov_b64 exec, -1
    s_waitcnt lgkmcnt(0)
    s_setpc_b64 s[40:41]
F_last:
    ds_read_b128 v[84:87], v108 offset:0
    ds_read_b128 v[88:91], v109 offset:0
    ds_read_b128 v[92:95], v108 offset:128
    ds_read_b128 v[96:99], v109 offset:128
    ds_read_b128 v[100:103], v108 offset:256
    ds_read_b128 v[104:107], v109 offset:256
    v_mov_b32 v53, 0xff800000
    v_mov_b32 v159, 0
    s_waitcnt lgkmcnt(5)
    v_mfma_f32_16x16x32_bf16 v[132:135], v[168:171], v[84:87], 0
    ds_read_b128 v[168:171], v24 offset:0
    s_waitcnt lgkmcnt(5)
    v_mfma_f32_16x16x32_bf16 v[132:135], v[172:175], v[88:91], v[132:135]
    ds_read_b128 v[172:175], v25 offset:0
    s_waitcnt lgkmcnt(5)
    v_mfma_f32_16x16x32_bf16 v[132:135], v[176:179], v[92:95], v[132:135]
    ds_read_b128 v[176:179], v24 offset:128
    s_waitcnt lgkmcnt(5)
    v_mfma_f32_16x16x32_bf16 v[132:135], v[180:183], v[96:99], v[132:135]
    ds_read_b128 v[180:183], v25 offset:128
    s_waitcnt lgkmcnt(5)
    v_mfma_f32_16x16x32_bf16 v[132:135], v[184:187], v[100:103], v[132:135]
    ds_read_b128 v[184:187], v24 offset:256
    s_waitcnt lgkmcnt(5)
    v_mfma_f32_16x16x32_bf16 v[132:135], v[188:191], v[104:107], v[132:135]
    ds_read_b128 v[188:191], v25 offset:256
    v_mfma_f32_16x16x32_bf16 v[136:139], v[192:195], v[84:87], 0
    ds_read_b128 v[192:195], v26 offset:0
    v_mfma_f32_16x16x32_bf16 v[136:139], v[196:199], v[88:91], v[136:139]
    ds_read_b128 v[196:199], v27 offset:0
    v_mfma_f32_16x16x32_bf16 v[136:139], v[200:203], v[92:95], v[136:139]
    ds_read_b128 v[200:203], v26 offset:128
    v_mfma_f32_16x16x32_bf16 v[136:139], v[204:207], v[96:99], v[136:139]
    ds_read_b128 v[204:207], v27 offset:128
    v_mfma_f32_16x16x32_bf16 v[136:139], v[208:211], v[100:103], v[136:139]
    ds_read_b128 v[208:211], v26 offset:256
    v_mfma_f32_16x16x32_bf16 v[136:139], v[212:215], v[104:107], v[136:139]
    ds_read_b128 v[212:215], v27 offset:256
    s_waitcnt lgkmcnt(10)
    v_mfma_f32_16x16x32_bf16 v[140:143], v[168:171], v[84:87], 0
    ds_read_b128 v[168:171], v28 offset:0
    v_cndmask_b32 v132, v53, v132, s[50:51]
    v_mfma_f32_16x16x32_bf16 v[140:143], v[172:175], v[88:91], v[140:143]
    ds_read_b128 v[172:175], v29 offset:0
    v_cndmask_b32 v133, v53, v133, s[52:53]
    s_waitcnt lgkmcnt(10)
    v_mfma_f32_16x16x32_bf16 v[140:143], v[176:179], v[92:95], v[140:143]
    ds_read_b128 v[176:179], v28 offset:128
    v_cndmask_b32 v134, v53, v134, s[54:55]
    v_mfma_f32_16x16x32_bf16 v[140:143], v[180:183], v[96:99], v[140:143]
    ds_read_b128 v[180:183], v29 offset:128
    v_cndmask_b32 v135, v53, v135, s[56:57]
    s_waitcnt lgkmcnt(10)
    v_mfma_f32_16x16x32_bf16 v[140:143], v[184:187], v[100:103], v[140:143]
    ds_read_b128 v[184:187], v28 offset:256
    v_max3_f32 v50, v132, v133, v134
    v_mfma_f32_16x16x32_bf16 v[140:143], v[188:191], v[104:107], v[140:143]
    ds_read_b128 v[188:191], v29 offset:256
    v_max3_f32 v50, v50, v135, v136
    v_mfma_f32_16x16x32_bf16 v[152:155], v[60:63], v[84:87], 0
    v_max3_f32 v50, v50, v137, v138
    v_mfma_f32_16x16x32_bf16 v[152:155], v[64:67], v[88:91], v[152:155]
    v_max_f32 v50, v50, v139
    v_mfma_f32_16x16x32_bf16 v[152:155], v[68:71], v[92:95], v[152:155]
    v_mfma_f32_16x16x32_bf16 v[152:155], v[72:75], v[96:99], v[152:155]
    v_mfma_f32_16x16x32_bf16 v[152:155], v[76:79], v[100:103], v[152:155]
    v_mfma_f32_16x16x32_bf16 v[152:155], v[80:83], v[104:107], v[152:155]
    s_waitcnt lgkmcnt(10)
    v_mfma_f32_16x16x32_bf16 v[144:147], v[192:195], v[84:87], 0
    v_mfma_f32_16x16x32_bf16 v[144:147], v[196:199], v[88:91], v[144:147]
    s_waitcnt lgkmcnt(8)
    v_mfma_f32_16x16x32_bf16 v[144:147], v[200:203], v[92:95], v[144:147]
    v_max3_f32 v50, v50, v140, v141
    v_mfma_f32_16x16x32_bf16 v[144:147], v[204:207], v[96:99], v[144:147]
    v_max3_f32 v50, v50, v142, v143
    s_waitcnt lgkmcnt(6)
    v_mfma_f32_16x16x32_bf16 v[144:147], v[208:211], v[100:103], v[144:147]
    v_cndmask_b32 v152, v53, v152, s[90:91]
    v_mfma_f32_16x16x32_bf16 v[144:147], v[212:215], v[104:107], v[144:147]
    v_max_f32 v50, v50, v152
    s_waitcnt lgkmcnt(4)
    v_mfma_f32_16x16x32_bf16 v[148:151], v[168:171], v[84:87], 0
    v_mfma_f32_16x16x32_bf16 v[148:151], v[172:175], v[88:91], v[148:151]
    s_waitcnt lgkmcnt(2)
    v_mfma_f32_16x16x32_bf16 v[148:151], v[176:179], v[92:95], v[148:151]
    v_mfma_f32_16x16x32_bf16 v[148:151], v[180:183], v[96:99], v[148:151]
    s_waitcnt lgkmcnt(0)
    v_mfma_f32_16x16x32_bf16 v[148:151], v[184:187], v[100:103], v[148:151]
    v_max3_f32 v50, v50, v144, v145
    v_mfma_f32_16x16x32_bf16 v[148:151], v[188:191], v[104:107], v[148:151]
    v_max3_f32 v50, v50, v146, v147
    ds_read_b64_tr_b16 v[220:221], v30 offset:0
    ds_read_b64_tr_b16 v[222:223], v19 offset:0
    ds_read_b64_tr_b16 v[224:225], v31 offset:0
    ds_read_b64_tr_b16 v[226:227], v19 offset:32
    ds_read_b64_tr_b16 v[228:229], v32 offset:0
    ds_read_b64_tr_b16 v[230:231], v19 offset:64
    ds_read_b64_tr_b16 v[232:233], v33 offset:0
    ds_read_b64_tr_b16 v[234:235], v19 offset:96
    v_cndmask_b32 v148, v53, v148, s[58:59]
    v_cndmask_b32 v149, v53, v149, s[60:61]
    v_cndmask_b32 v150, v53, v150, s[62:63]
    v_cndmask_b32 v151, v53, v151, s[64:65]
    v_max3_f32 v50, v50, v148, v149
    v_max3_f32 v50, v50, v150, v151
    v_mov_b32 v51, v50
    ds_read_b64_tr_b16 v[236:237], v34 offset:0
    ds_read_b64_tr_b16 v[238:239], v38 offset:0
    v_permlane32_swap_b32 v50, v51
    v_max_f32 v50, v50, v51
    v_mov_b32 v51, v50
    ds_read_b64_tr_b16 v[240:241], v35 offset:0
    ds_read_b64_tr_b16 v[242:243], v39 offset:0
    v_permlane16_swap_b32 v50, v51
    v_max_f32 v50, v50, v51
    v_mul_f32 v51, s42, v50
    ds_read_b64_tr_b16 v[244:245], v36 offset:0
    ds_read_b64_tr_b16 v[246:247], v40 offset:0
    v_fma_f32 v132, v132, s42, -v51
    v_fma_f32 v133, v133, s42, -v51
    v_fma_f32 v134, v134, s42, -v51
    v_fma_f32 v135, v135, s42, -v51
    v_fma_f32 v152, v152, s42, -v51
    v_exp_f32 v132, v132
    v_exp_f32 v133, v133
    v_exp_f32 v134, v134
    v_exp_f32 v135, v135
    v_exp_f32 v152, v152
    v_cvt_pk_bf16_f32 v156, v132, v133
    v_cvt_pk_bf16_f32 v157, v134, v135
    v_cvt_pk_bf16_f32 v158, v152, 0
    v_fma_f32 v136, v136, s42, -v51
    v_fma_f32 v137, v137, s42, -v51
    v_mfma_f32_16x16x32_bf16 v[216:219], v[56:59], v[156:159], 0
    s_waitcnt lgkmcnt(10)
    v_mfma_f32_16x16x32_bf16 v[168:171], v[220:223], v[156:159], 0
    ds_read_b64_tr_b16 v[248:249], v37 offset:0
    ds_read_b64_tr_b16 v[250:251], v41 offset:0
    v_fma_f32 v138, v138, s42, -v51
    v_fma_f32 v139, v139, s42, -v51
    v_fma_f32 v140, v140, s42, -v51
    v_fma_f32 v141, v141, s42, -v51
    v_fma_f32 v142, v142, s42, -v51
    v_mfma_f32_16x16x32_bf16 v[172:175], v[224:227], v[156:159], 0
    ds_read_b64_tr_b16 v[220:221], v42 offset:0
    ds_read_b64_tr_b16 v[222:223], v46 offset:0
    v_fma_f32 v143, v143, s42, -v51
    v_exp_f32 v136, v136
    v_exp_f32 v137, v137
    v_exp_f32 v138, v138
    v_exp_f32 v139, v139
    s_waitcnt lgkmcnt(10)
    v_mfma_f32_16x16x32_bf16 v[176:179], v[228:231], v[156:159], 0
    ds_read_b64_tr_b16 v[224:225], v43 offset:0
    ds_read_b64_tr_b16 v[226:227], v47 offset:0
    v_exp_f32 v140, v140
    v_exp_f32 v141, v141
    v_exp_f32 v142, v142
    v_exp_f32 v143, v143
    v_cvt_pk_bf16_f32 v160, v136, v137
    v_mfma_f32_16x16x32_bf16 v[180:183], v[232:235], v[156:159], 0
    ds_read_b64_tr_b16 v[228:229], v44 offset:0
    ds_read_b64_tr_b16 v[230:231], v48 offset:0
    v_cvt_pk_bf16_f32 v161, v138, v139
    v_cvt_pk_bf16_f32 v162, v140, v141
    v_cvt_pk_bf16_f32 v163, v142, v143
    v_fma_f32 v144, v144, s42, -v51
    v_fma_f32 v145, v145, s42, -v51
    v_mfma_f32_16x16x32_bf16 v[216:219], v[56:59], v[160:163], v[216:219]
    s_waitcnt lgkmcnt(10)
    v_mfma_f32_16x16x32_bf16 v[168:171], v[236:239], v[160:163], v[168:171]
    ds_read_b64_tr_b16 v[232:233], v45 offset:0
    ds_read_b64_tr_b16 v[234:235], v49 offset:0
    v_fma_f32 v146, v146, s42, -v51
    v_fma_f32 v147, v147, s42, -v51
    v_fma_f32 v148, v148, s42, -v51
    v_fma_f32 v149, v149, s42, -v51
    v_fma_f32 v150, v150, s42, -v51
    v_mfma_f32_16x16x32_bf16 v[172:175], v[240:243], v[160:163], v[172:175]
    ds_read_b64_tr_b16 v[236:237], v30 offset:128
    ds_read_b64_tr_b16 v[238:239], v19 offset:128
    v_fma_f32 v151, v151, s42, -v51
    v_exp_f32 v144, v144
    v_exp_f32 v145, v145
    v_exp_f32 v146, v146
    v_exp_f32 v147, v147
    s_waitcnt lgkmcnt(10)
    v_mfma_f32_16x16x32_bf16 v[176:179], v[244:247], v[160:163], v[176:179]
    ds_read_b64_tr_b16 v[240:241], v31 offset:128
    ds_read_b64_tr_b16 v[242:243], v19 offset:160
    v_exp_f32 v148, v148
    v_exp_f32 v149, v149
    v_exp_f32 v150, v150
    v_exp_f32 v151, v151
    v_cvt_pk_bf16_f32 v164, v144, v145
    v_mfma_f32_16x16x32_bf16 v[180:183], v[248:251], v[160:163], v[180:183]
    ds_read_b64_tr_b16 v[244:245], v32 offset:128
    ds_read_b64_tr_b16 v[246:247], v19 offset:192
    v_cvt_pk_bf16_f32 v165, v146, v147
    v_cvt_pk_bf16_f32 v166, v148, v149
    v_cvt_pk_bf16_f32 v167, v150, v151
    s_waitcnt lgkmcnt(10)
    s_nop 0
    v_mfma_f32_16x16x32_bf16 v[168:171], v[220:223], v[164:167], v[168:171]
    ds_read_b64_tr_b16 v[248:249], v33 offset:128
    ds_read_b64_tr_b16 v[250:251], v19 offset:224
    v_mfma_f32_16x16x32_bf16 v[216:219], v[56:59], v[164:167], v[216:219]
    v_mfma_f32_16x16x32_bf16 v[172:175], v[224:227], v[164:167], v[172:175]
    ds_read_b64_tr_b16 v[220:221], v34 offset:128
    ds_read_b64_tr_b16 v[222:223], v38 offset:128
    s_waitcnt lgkmcnt(10)
    v_mfma_f32_16x16x32_bf16 v[176:179], v[228:231], v[164:167], v[176:179]
    ds_read_b64_tr_b16 v[224:225], v35 offset:128
    ds_read_b64_tr_b16 v[226:227], v39 offset:128
    v_mfma_f32_16x16x32_bf16 v[180:183], v[232:235], v[164:167], v[180:183]
    ds_read_b64_tr_b16 v[228:229], v36 offset:128
    ds_read_b64_tr_b16 v[230:231], v40 offset:128
    v_rcp_f32 v50, v216
    s_waitcnt lgkmcnt(10)
    v_mfma_f32_16x16x32_bf16 v[184:187], v[236:239], v[156:159], 0
    ds_read_b64_tr_b16 v[232:233], v37 offset:128
    ds_read_b64_tr_b16 v[234:235], v41 offset:128
    v_mul_f32 v168, v50, v168
    v_mul_f32 v169, v50, v169
    v_mul_f32 v170, v50, v170
    v_mul_f32 v171, v50, v171
    v_mfma_f32_16x16x32_bf16 v[188:191], v[240:243], v[156:159], 0
    ds_read_b64_tr_b16 v[236:237], v42 offset:128
    ds_read_b64_tr_b16 v[238:239], v46 offset:128
    v_cvt_pk_bf16_f32 v168, v168, v169
    v_cvt_pk_bf16_f32 v169, v170, v171
    ds_write_b64 v7, v[168:169] offset:0
    v_mul_f32 v172, v50, v172
    s_waitcnt lgkmcnt(11)
    v_mfma_f32_16x16x32_bf16 v[192:195], v[244:247], v[156:159], 0
    ds_read_b64_tr_b16 v[240:241], v43 offset:128
    ds_read_b64_tr_b16 v[242:243], v47 offset:128
    v_mul_f32 v173, v50, v173
    v_mul_f32 v174, v50, v174
    v_mul_f32 v175, v50, v175
    v_cvt_pk_bf16_f32 v172, v172, v173
    v_mfma_f32_16x16x32_bf16 v[196:199], v[248:251], v[156:159], 0
    ds_read_b64_tr_b16 v[244:245], v44 offset:128
    ds_read_b64_tr_b16 v[246:247], v48 offset:128
    v_cvt_pk_bf16_f32 v173, v174, v175
    s_waitcnt lgkmcnt(14)
    ds_write_b64 v8, v[172:173] offset:0
    v_mul_f32 v176, v50, v176
    v_mul_f32 v177, v50, v177
    s_waitcnt lgkmcnt(12)
    v_mfma_f32_16x16x32_bf16 v[184:187], v[220:223], v[160:163], v[184:187]
    ds_read_b64_tr_b16 v[248:249], v45 offset:128
    ds_read_b64_tr_b16 v[250:251], v49 offset:128
    v_mul_f32 v178, v50, v178
    v_mul_f32 v179, v50, v179
    v_cvt_pk_bf16_f32 v176, v176, v177
    v_cvt_pk_bf16_f32 v177, v178, v179
    v_mfma_f32_16x16x32_bf16 v[188:191], v[224:227], v[160:163], v[188:191]
    ds_read_b64_tr_b16 v[220:221], v30 offset:256
    s_waitcnt lgkmcnt(14)
    ds_read_b64_tr_b16 v[222:223], v19 offset:256
    s_waitcnt lgkmcnt(14)
    ds_write_b64 v9, v[176:177] offset:0
    v_mul_f32 v180, v50, v180
    v_mul_f32 v181, v50, v181
    v_mul_f32 v182, v50, v182
    v_mfma_f32_16x16x32_bf16 v[192:195], v[228:231], v[160:163], v[192:195]
    s_waitcnt lgkmcnt(14)
    ds_read_b64_tr_b16 v[224:225], v31 offset:256
    s_waitcnt lgkmcnt(14)
    ds_read_b64_tr_b16 v[226:227], v19 offset:288
    v_mul_f32 v183, v50, v183
    v_cvt_pk_bf16_f32 v180, v180, v181
    v_cvt_pk_bf16_f32 v181, v182, v183
    s_waitcnt lgkmcnt(14)
    ds_write_b64 v10, v[180:181] offset:0
    v_mfma_f32_16x16x32_bf16 v[196:199], v[232:235], v[160:163], v[196:199]
    s_waitcnt lgkmcnt(14)
    ds_read_b64_tr_b16 v[228:229], v32 offset:256
    s_waitcnt lgkmcnt(14)
    ds_read_b64_tr_b16 v[230:231], v19 offset:320
    s_waitcnt lgkmcnt(14)
    ds_read_b128 v[132:135], v11 offset:0
    s_waitcnt lgkmcnt(14)
    ds_read_b128 v[136:139], v12 offset:1024
    v_mfma_f32_16x16x32_bf16 v[184:187], v[236:239], v[164:167], v[184:187]
    s_waitcnt lgkmcnt(14)
    ds_read_b64_tr_b16 v[232:233], v33 offset:256
    s_waitcnt lgkmcnt(14)
    ds_read_b64_tr_b16 v[234:235], v19 offset:352
    v_mfma_f32_16x16x32_bf16 v[188:191], v[240:243], v[164:167], v[188:191]
    s_waitcnt lgkmcnt(14)
    ds_read_b64_tr_b16 v[236:237], v34 offset:256
    s_waitcnt lgkmcnt(14)
    ds_read_b64_tr_b16 v[238:239], v38 offset:256
    v_mfma_f32_16x16x32_bf16 v[192:195], v[244:247], v[164:167], v[192:195]
    s_waitcnt lgkmcnt(14)
    ds_read_b64_tr_b16 v[240:241], v35 offset:256
    s_waitcnt lgkmcnt(14)
    ds_read_b64_tr_b16 v[242:243], v39 offset:256
    v_mfma_f32_16x16x32_bf16 v[196:199], v[248:251], v[164:167], v[196:199]
    s_waitcnt lgkmcnt(14)
    ds_read_b64_tr_b16 v[244:245], v36 offset:256
    s_waitcnt lgkmcnt(14)
    ds_read_b64_tr_b16 v[246:247], v40 offset:256
    s_waitcnt lgkmcnt(9)
    buffer_store_dwordx4 v[132:135], v5, s[16:19], s43 offen offset:0 sc1
    s_waitcnt lgkmcnt(8)
    buffer_store_dwordx4 v[136:139], v5, s[16:19], s43 offen offset:3072 sc1
    v_mfma_f32_16x16x32_bf16 v[200:203], v[220:223], v[156:159], 0
    ds_read_b64_tr_b16 v[248:249], v37 offset:256
    ds_read_b64_tr_b16 v[250:251], v41 offset:256
    v_mul_f32 v184, v50, v184
    v_mul_f32 v185, v50, v185
    v_mul_f32 v186, v50, v186
    v_mul_f32 v187, v50, v187
    v_mfma_f32_16x16x32_bf16 v[204:207], v[224:227], v[156:159], 0
    ds_read_b64_tr_b16 v[220:221], v42 offset:256
    ds_read_b64_tr_b16 v[222:223], v46 offset:256
    v_cvt_pk_bf16_f32 v184, v184, v185
    v_cvt_pk_bf16_f32 v185, v186, v187
    ds_write_b64 v7, v[184:185] offset:2048
    v_mul_f32 v188, v50, v188
    v_mfma_f32_16x16x32_bf16 v[208:211], v[228:231], v[156:159], 0
    ds_read_b64_tr_b16 v[224:225], v43 offset:256
    ds_read_b64_tr_b16 v[226:227], v47 offset:256
    v_mul_f32 v189, v50, v189
    v_mul_f32 v190, v50, v190
    v_mul_f32 v191, v50, v191
    v_cvt_pk_bf16_f32 v188, v188, v189
    s_waitcnt lgkmcnt(11)
    v_mfma_f32_16x16x32_bf16 v[212:215], v[232:235], v[156:159], 0
    ds_read_b64_tr_b16 v[228:229], v44 offset:256
    ds_read_b64_tr_b16 v[230:231], v48 offset:256
    v_cvt_pk_bf16_f32 v189, v190, v191
    ds_write_b64 v8, v[188:189] offset:2048
    v_mul_f32 v192, v50, v192
    v_mul_f32 v193, v50, v193
    v_mfma_f32_16x16x32_bf16 v[200:203], v[236:239], v[160:163], v[200:203]
    ds_read_b64_tr_b16 v[232:233], v45 offset:256
    s_waitcnt lgkmcnt(14)
    ds_read_b64_tr_b16 v[234:235], v49 offset:256
    v_mul_f32 v194, v50, v194
    v_mul_f32 v195, v50, v195
    v_cvt_pk_bf16_f32 v192, v192, v193
    v_cvt_pk_bf16_f32 v193, v194, v195
    s_waitcnt lgkmcnt(12)
    v_mfma_f32_16x16x32_bf16 v[204:207], v[240:243], v[160:163], v[204:207]
    ds_write_b64 v9, v[192:193] offset:2048
    v_mul_f32 v196, v50, v196
    v_mul_f32 v197, v50, v197
    v_mul_f32 v198, v50, v198
    v_mfma_f32_16x16x32_bf16 v[208:211], v[244:247], v[160:163], v[208:211]
    v_mul_f32 v199, v50, v199
    v_cvt_pk_bf16_f32 v196, v196, v197
    v_cvt_pk_bf16_f32 v197, v198, v199
    ds_write_b64 v10, v[196:197] offset:2048
    s_waitcnt lgkmcnt(10)
    v_mfma_f32_16x16x32_bf16 v[212:215], v[248:251], v[160:163], v[212:215]
    ds_read_b128 v[140:143], v11 offset:2048
    ds_read_b128 v[144:147], v12 offset:3072
    v_mfma_f32_16x16x32_bf16 v[200:203], v[220:223], v[164:167], v[200:203]
    s_waitcnt lgkmcnt(9)
    v_mfma_f32_16x16x32_bf16 v[204:207], v[224:227], v[164:167], v[204:207]
    s_waitcnt lgkmcnt(7)
    v_mfma_f32_16x16x32_bf16 v[208:211], v[228:231], v[164:167], v[208:211]
    s_waitcnt lgkmcnt(4)
    v_mfma_f32_16x16x32_bf16 v[212:215], v[232:235], v[164:167], v[212:215]
    s_waitcnt lgkmcnt(1)
    buffer_store_dwordx4 v[140:143], v5, s[16:19], s43 offen offset:128 sc1
    s_waitcnt lgkmcnt(0)
    buffer_store_dwordx4 v[144:147], v5, s[16:19], s43 offen offset:3200 sc1
    v_mul_f32 v200, v50, v200
    v_mul_f32 v201, v50, v201
    v_mul_f32 v202, v50, v202
    v_mul_f32 v203, v50, v203
    v_cvt_pk_bf16_f32 v200, v200, v201
    v_cvt_pk_bf16_f32 v201, v202, v203
    ds_write_b64 v7, v[200:201] offset:4096
    v_mul_f32 v204, v50, v204
    v_mul_f32 v205, v50, v205
    v_mul_f32 v206, v50, v206
    v_mul_f32 v207, v50, v207
    v_cvt_pk_bf16_f32 v204, v204, v205
    v_cvt_pk_bf16_f32 v205, v206, v207
    ds_write_b64 v8, v[204:205] offset:4096
    v_mul_f32 v208, v50, v208
    v_mul_f32 v209, v50, v209
    v_mul_f32 v210, v50, v210
    v_mul_f32 v211, v50, v211
    v_cvt_pk_bf16_f32 v208, v208, v209
    v_cvt_pk_bf16_f32 v209, v210, v211
    ds_write_b64 v9, v[208:209] offset:4096
    v_mul_f32 v212, v50, v212
    v_mul_f32 v213, v50, v213
    v_mul_f32 v214, v50, v214
    v_mul_f32 v215, v50, v215
    v_cvt_pk_bf16_f32 v212, v212, v213
    v_cvt_pk_bf16_f32 v213, v214, v215
    ds_write_b64 v10, v[212:213] offset:4096
    ds_read_b128 v[148:151], v11 offset:4096
    ds_read_b128 v[152:155], v12 offset:5120
    s_waitcnt lgkmcnt(1)
    buffer_store_dwordx4 v[148:151], v5, s[16:19], s43 offen offset:256 sc1
    s_waitcnt lgkmcnt(0)
    buffer_store_dwordx4 v[152:155], v5, s[16:19], s43 offen offset:3328 sc1
    s_waitcnt lgkmcnt(0)
    s_setpc_b64 s[40:41]
L_storer:
    s_cmp_eq_u32 s30, 0
    s_cselect_b32 s94, 0xffff, 0
    s_mov_b32 s95, 0
    v_bfrev_b32 v52, 1
    v_cndmask_b32 v6, v5, v52, s[94:95]
    s_mov_b32 s43, s48
    v_mov_b32 v2, 161792
    v_mov_b32 v3, 1
L_sp35:
    ds_read_b32 v253, v2 offset:80
    s_sub_u32 s46, s46, 1
    s_cbranch_scc1 L_sx35
    s_waitcnt lgkmcnt(0)
    v_readfirstlane_b32 s44, v253
    s_nop 1
    s_cmp_gt_u32 s44, 0
    s_cbranch_scc0 L_sp35
    s_branch L_sy35
L_sx35:
    s_mov_b32 s46, 0
    s_waitcnt lgkmcnt(0)
L_sy35:
    ds_read_b128 v[16:19], v11 offset:0
    ds_read_b128 v[20:23], v12 offset:1024
    ds_read_b128 v[24:27], v11 offset:2048
    ds_read_b128 v[28:31], v12 offset:3072
    ds_read_b128 v[32:35], v11 offset:4096
    ds_read_b128 v[36:39], v12 offset:5120
    s_mov_b64 exec, 1
    ds_write_b32 v2, v3 offset:96
    s_mov_b64 exec, -1
    s_waitcnt lgkmcnt(6)
    buffer_store_dwordx4 v[16:19], v6, s[16:19], s43 offen offset:0 sc1
    s_waitcnt lgkmcnt(5)
    buffer_store_dwordx4 v[20:23], v5, s[16:19], s43 offen offset:3072 sc1
    s_waitcnt lgkmcnt(4)
    buffer_store_dwordx4 v[24:27], v6, s[16:19], s43 offen offset:128 sc1
    s_waitcnt lgkmcnt(3)
    buffer_store_dwordx4 v[28:31], v5, s[16:19], s43 offen offset:3200 sc1
    s_waitcnt lgkmcnt(2)
    buffer_store_dwordx4 v[32:35], v6, s[16:19], s43 offen offset:256 sc1
    s_waitcnt lgkmcnt(1)
    buffer_store_dwordx4 v[36:39], v5, s[16:19], s43 offen offset:3328 sc1
    s_add_u32 s43, s43, s33
    s_waitcnt lgkmcnt(0)
    v_mov_b32 v3, 1
L_sp36:
    ds_read_b32 v253, v2 offset:84
    s_sub_u32 s46, s46, 1
    s_cbranch_scc1 L_sx36
    s_waitcnt lgkmcnt(0)
    v_readfirstlane_b32 s44, v253
    s_nop 1
    s_cmp_gt_u32 s44, 0
    s_cbranch_scc0 L_sp36
    s_branch L_sy36
L_sx36:
    s_mov_b32 s46, 0
    s_waitcnt lgkmcnt(0)
L_sy36:
    ds_read_b128 v[16:19], v11 offset:6144
    ds_read_b128 v[20:23], v12 offset:7168
    ds_read_b128 v[24:27], v11 offset:8192
    ds_read_b128 v[28:31], v12 offset:9216
    ds_read_b128 v[32:35], v11 offset:10240
    ds_read_b128 v[36:39], v12 offset:11264
    s_mov_b64 exec, 1
    ds_write_b32 v2, v3 offset:100
    s_mov_b64 exec, -1
    s_waitcnt lgkmcnt(6)
    buffer_store_dwordx4 v[16:19], v5, s[16:19], s43 offen offset:0 sc1
    s_waitcnt lgkmcnt(5)
    buffer_store_dwordx4 v[20:23], v5, s[16:19], s43 offen offset:3072 sc1
    s_waitcnt lgkmcnt(4)
    buffer_store_dwordx4 v[24:27], v5, s[16:19], s43 offen offset:128 sc1
    s_waitcnt lgkmcnt(3)
    buffer_store_dwordx4 v[28:31], v5, s[16:19], s43 offen offset:3200 sc1
    s_waitcnt lgkmcnt(2)
    buffer_store_dwordx4 v[32:35], v5, s[16:19], s43 offen offset:256 sc1
    s_waitcnt lgkmcnt(1)
    buffer_store_dwordx4 v[36:39], v5, s[16:19], s43 offen offset:3328 sc1
    s_add_u32 s43, s43, s33
    s_waitcnt lgkmcnt(0)
    v_mov_b32 v3, 1
L_sp37:
    ds_read_b32 v253, v2 offset:88
    s_sub_u32 s46, s46, 1
    s_cbranch_scc1 L_sx37
    s_waitcnt lgkmcnt(0)
    v_readfirstlane_b32 s44, v253
    s_nop 1
    s_cmp_gt_u32 s44, 0
    s_cbranch_scc0 L_sp37
    s_branch L_sy37
L_sx37:
    s_mov_b32 s46, 0
    s_waitcnt lgkmcnt(0)
L_sy37:
    ds_read_b128 v[16:19], v11 offset:12288
    ds_read_b128 v[20:23], v12 offset:13312
    ds_read_b128 v[24:27], v11 offset:14336
    ds_read_b128 v[28:31], v12 offset:15360
    ds_read_b128 v[32:35], v11 offset:16384
    ds_read_b128 v[36:39], v12 offset:17408
    s_mov_b64 exec, 1
    ds_write_b32 v2, v3 offset:104
    s_mov_b64 exec, -1
    s_waitcnt lgkmcnt(6)
    buffer_store_dwordx4 v[16:19], v5, s[16:19], s43 offen offset:0 sc1
    s_waitcnt lgkmcnt(5)
    buffer_store_dwordx4 v[20:23], v5, s[16:19], s43 offen offset:3072 sc1
    s_waitcnt lgkmcnt(4)
    buffer_store_dwordx4 v[24:27], v5, s[16:19], s43 offen offset:128 sc1
    s_waitcnt lgkmcnt(3)
    buffer_store_dwordx4 v[28:31], v5, s[16:19], s43 offen offset:3200 sc1
    s_waitcnt lgkmcnt(2)
    buffer_store_dwordx4 v[32:35], v5, s[16:19], s43 offen offset:256 sc1
    s_waitcnt lgkmcnt(1)
    buffer_store_dwordx4 v[36:39], v5, s[16:19], s43 offen offset:3328 sc1
    s_add_u32 s43, s43, s33
    s_waitcnt lgkmcnt(0)
    v_mov_b32 v3, 1
L_sp38:
    ds_read_b32 v253, v2 offset:92
    s_sub_u32 s46, s46, 1
    s_cbranch_scc1 L_sx38
    s_waitcnt lgkmcnt(0)
    v_readfirstlane_b32 s44, v253
    s_nop 1
    s_cmp_gt_u32 s44, 0
    s_cbranch_scc0 L_sp38
    s_branch L_sy38
L_sx38:
    s_mov_b32 s46, 0
    s_waitcnt lgkmcnt(0)
L_sy38:
    ds_read_b128 v[16:19], v11 offset:18432
    ds_read_b128 v[20:23], v12 offset:19456
    ds_read_b128 v[24:27], v11 offset:20480
    ds_read_b128 v[28:31], v12 offset:21504
    ds_read_b128 v[32:35], v11 offset:22528
    ds_read_b128 v[36:39], v12 offset:23552
    s_mov_b64 exec, 1
    ds_write_b32 v2, v3 offset:108
    s_mov_b64 exec, -1
    s_waitcnt lgkmcnt(6)
    buffer_store_dwordx4 v[16:19], v5, s[16:19], s43 offen offset:0 sc1
    s_waitcnt lgkmcnt(5)
    buffer_store_dwordx4 v[20:23], v5, s[16:19], s43 offen offset:3072 sc1
    s_waitcnt lgkmcnt(4)
    buffer_store_dwordx4 v[24:27], v5, s[16:19], s43 offen offset:128 sc1
    s_waitcnt lgkmcnt(3)
    buffer_store_dwordx4 v[28:31], v5, s[16:19], s43 offen offset:3200 sc1
    s_waitcnt lgkmcnt(2)
    buffer_store_dwordx4 v[32:35], v5, s[16:19], s43 offen offset:256 sc1
    s_waitcnt lgkmcnt(1)
    buffer_store_dwordx4 v[36:39], v5, s[16:19], s43 offen offset:3328 sc1
    s_add_u32 s43, s43, s33
    s_waitcnt lgkmcnt(0)
    v_mov_b32 v3, 2
L_sp39:
    ds_read_b32 v253, v2 offset:80
    s_sub_u32 s46, s46, 1
    s_cbranch_scc1 L_sx39
    s_waitcnt lgkmcnt(0)
    v_readfirstlane_b32 s44, v253
    s_nop 1
    s_cmp_gt_u32 s44, 1
    s_cbranch_scc0 L_sp39
    s_branch L_sy39
L_sx39:
    s_mov_b32 s46, 0
    s_waitcnt lgkmcnt(0)
L_sy39:
    ds_read_b128 v[16:19], v11 offset:0
    ds_read_b128 v[20:23], v12 offset:1024
    ds_read_b128 v[24:27], v11 offset:2048
    ds_read_b128 v[28:31], v12 offset:3072
    ds_read_b128 v[32:35], v11 offset:4096
    ds_read_b128 v[36:39], v12 offset:5120
    s_mov_b64 exec, 1
    ds_write_b32 v2, v3 offset:96
    s_mov_b64 exec, -1
    s_waitcnt lgkmcnt(6)
    buffer_store_dwordx4 v[16:19], v5, s[16:19], s43 offen offset:0 sc1
    s_waitcnt lgkmcnt(5)
    buffer_store_dwordx4 v[20:23], v5, s[16:19], s43 offen offset:3072 sc1
    s_waitcnt lgkmcnt(4)
    buffer_store_dwordx4 v[24:27], v5, s[16:19], s43 offen offset:128 sc1
    s_waitcnt lgkmcnt(3)
    buffer_store_dwordx4 v[28:31], v5, s[16:19], s43 offen offset:3200 sc1
    s_waitcnt lgkmcnt(2)
    buffer_store_dwordx4 v[32:35], v5, s[16:19], s43 offen offset:256 sc1
    s_waitcnt lgkmcnt(1)
    buffer_store_dwordx4 v[36:39], v5, s[16:19], s43 offen offset:3328 sc1
    s_add_u32 s43, s43, s33
    s_waitcnt lgkmcnt(0)
    v_mov_b32 v3, 2
L_sp40:
    ds_read_b32 v253, v2 offset:84
    s_sub_u32 s46, s46, 1
    s_cbranch_scc1 L_sx40
    s_waitcnt lgkmcnt(0)
    v_readfirstlane_b32 s44, v253
    s_nop 1
    s_cmp_gt_u32 s44, 1
    s_cbranch_scc0 L_sp40
    s_branch L_sy40
L_sx40:
    s_mov_b32 s46, 0
    s_waitcnt lgkmcnt(0)
L_sy40:
    ds_read_b128 v[16:19], v11 offset:6144
    ds_read_b128 v[20:23], v12 offset:7168
    ds_read_b128 v[24:27], v11 offset:8192
    ds_read_b128 v[28:31], v12 offset:9216
    ds_read_b128 v[32:35], v11 offset:10240
    ds_read_b128 v[36:39], v12 offset:11264
    s_mov_b64 exec, 1
    ds_write_b32 v2, v3 offset:100
    s_mov_b64 exec, -1
    s_waitcnt lgkmcnt(6)
    buffer_store_dwordx4 v[16:19], v5, s[16:19], s43 offen offset:0 sc1
    s_waitcnt lgkmcnt(5)
    buffer_store_dwordx4 v[20:23], v5, s[16:19], s43 offen offset:3072 sc1
    s_waitcnt lgkmcnt(4)
    buffer_store_dwordx4 v[24:27], v5, s[16:19], s43 offen offset:128 sc1
    s_waitcnt lgkmcnt(3)
    buffer_store_dwordx4 v[28:31], v5, s[16:19], s43 offen offset:3200 sc1
    s_waitcnt lgkmcnt(2)
    buffer_store_dwordx4 v[32:35], v5, s[16:19], s43 offen offset:256 sc1
    s_waitcnt lgkmcnt(1)
    buffer_store_dwordx4 v[36:39], v5, s[16:19], s43 offen offset:3328 sc1
    s_add_u32 s43, s43, s33
    s_waitcnt lgkmcnt(0)
    v_mov_b32 v3, 2
L_sp41:
    ds_read_b32 v253, v2 offset:88
    s_sub_u32 s46, s46, 1
    s_cbranch_scc1 L_sx41
    s_waitcnt lgkmcnt(0)
    v_readfirstlane_b32 s44, v253
    s_nop 1
    s_cmp_gt_u32 s44, 1
    s_cbranch_scc0 L_sp41
    s_branch L_sy41
L_sx41:
    s_mov_b32 s46, 0
    s_waitcnt lgkmcnt(0)
L_sy41:
    ds_read_b128 v[16:19], v11 offset:12288
    ds_read_b128 v[20:23], v12 offset:13312
    ds_read_b128 v[24:27], v11 offset:14336
    ds_read_b128 v[28:31], v12 offset:15360
    ds_read_b128 v[32:35], v11 offset:16384
    ds_read_b128 v[36:39], v12 offset:17408
    s_mov_b64 exec, 1
    ds_write_b32 v2, v3 offset:104
    s_mov_b64 exec, -1
    s_waitcnt lgkmcnt(6)
    buffer_store_dwordx4 v[16:19], v5, s[16:19], s43 offen offset:0 sc1
    s_waitcnt lgkmcnt(5)
    buffer_store_dwordx4 v[20:23], v5, s[16:19], s43 offen offset:3072 sc1
    s_waitcnt lgkmcnt(4)
    buffer_store_dwordx4 v[24:27], v5, s[16:19], s43 offen offset:128 sc1
    s_waitcnt lgkmcnt(3)
    buffer_store_dwordx4 v[28:31], v5, s[16:19], s43 offen offset:3200 sc1
    s_waitcnt lgkmcnt(2)
    buffer_store_dwordx4 v[32:35], v5, s[16:19], s43 offen offset:256 sc1
    s_waitcnt lgkmcnt(1)
    buffer_store_dwordx4 v[36:39], v5, s[16:19], s43 offen offset:3328 sc1
    s_add_u32 s43, s43, s33
    s_waitcnt lgkmcnt(0)
    v_mov_b32 v3, 2
L_sp42:
    ds_read_b32 v253, v2 offset:92
    s_sub_u32 s46, s46, 1
    s_cbranch_scc1 L_sx42
    s_waitcnt lgkmcnt(0)
    v_readfirstlane_b32 s44, v253
    s_nop 1
    s_cmp_gt_u32 s44, 1
    s_cbranch_scc0 L_sp42
    s_branch L_sy42
L_sx42:
    s_mov_b32 s46, 0
    s_waitcnt lgkmcnt(0)
L_sy42:
    ds_read_b128 v[16:19], v11 offset:18432
    ds_read_b128 v[20:23], v12 offset:19456
    ds_read_b128 v[24:27], v11 offset:20480
    ds_read_b128 v[28:31], v12 offset:21504
    ds_read_b128 v[32:35], v11 offset:22528
    ds_read_b128 v[36:39], v12 offset:23552
    s_mov_b64 exec, 1
    ds_write_b32 v2, v3 offset:108
    s_mov_b64 exec, -1
    s_waitcnt lgkmcnt(6)
    buffer_store_dwordx4 v[16:19], v5, s[16:19], s43 offen offset:0 sc1
    s_waitcnt lgkmcnt(5)
    buffer_store_dwordx4 v[20:23], v5, s[16:19], s43 offen offset:3072 sc1
    s_waitcnt lgkmcnt(4)
    buffer_store_dwordx4 v[24:27], v5, s[16:19], s43 offen offset:128 sc1
    s_waitcnt lgkmcnt(3)
    buffer_store_dwordx4 v[28:31], v5, s[16:19], s43 offen offset:3200 sc1
    s_waitcnt lgkmcnt(2)
    buffer_store_dwordx4 v[32:35], v5, s[16:19], s43 offen offset:256 sc1
    s_waitcnt lgkmcnt(1)
    buffer_store_dwordx4 v[36:39], v5, s[16:19], s43 offen offset:3328 sc1
    s_add_u32 s43, s43, s33
    s_waitcnt lgkmcnt(0)
    v_mov_b32 v3, 3
L_sp43:
    ds_read_b32 v253, v2 offset:80
    s_sub_u32 s46, s46, 1
    s_cbranch_scc1 L_sx43
    s_waitcnt lgkmcnt(0)
    v_readfirstlane_b32 s44, v253
    s_nop 1
    s_cmp_gt_u32 s44, 2
    s_cbranch_scc0 L_sp43
    s_branch L_sy43
L_sx43:
    s_mov_b32 s46, 0
    s_waitcnt lgkmcnt(0)
L_sy43:
    ds_read_b128 v[16:19], v11 offset:0
    ds_read_b128 v[20:23], v12 offset:1024
    ds_read_b128 v[24:27], v11 offset:2048
    ds_read_b128 v[28:31], v12 offset:3072
    ds_read_b128 v[32:35], v11 offset:4096
    ds_read_b128 v[36:39], v12 offset:5120
    s_mov_b64 exec, 1
    ds_write_b32 v2, v3 offset:96
    s_mov_b64 exec, -1
    s_waitcnt lgkmcnt(6)
    buffer_store_dwordx4 v[16:19], v5, s[16:19], s43 offen offset:0 sc1
    s_waitcnt lgkmcnt(5)
    buffer_store_dwordx4 v[20:23], v5, s[16:19], s43 offen offset:3072 sc1
    s_waitcnt lgkmcnt(4)
    buffer_store_dwordx4 v[24:27], v5, s[16:19], s43 offen offset:128 sc1
    s_waitcnt lgkmcnt(3)
    buffer_store_dwordx4 v[28:31], v5, s[16:19], s43 offen offset:3200 sc1
    s_waitcnt lgkmcnt(2)
    buffer_store_dwordx4 v[32:35], v5, s[16:19], s43 offen offset:256 sc1
    s_waitcnt lgkmcnt(1)
    buffer_store_dwordx4 v[36:39], v5, s[16:19], s43 offen offset:3328 sc1
    s_add_u32 s43, s43, s33
    s_waitcnt lgkmcnt(0)
    v_mov_b32 v3, 3
L_sp44:
    ds_read_b32 v253, v2 offset:84
    s_sub_u32 s46, s46, 1
    s_cbranch_scc1 L_sx44
    s_waitcnt lgkmcnt(0)
    v_readfirstlane_b32 s44, v253
    s_nop 1
    s_cmp_gt_u32 s44, 2
    s_cbranch_scc0 L_sp44
    s_branch L_sy44
L_sx44:
    s_mov_b32 s46, 0
    s_waitcnt lgkmcnt(0)
L_sy44:
    ds_read_b128 v[16:19], v11 offset:6144
    ds_read_b128 v[20:23], v12 offset:7168
    ds_read_b128 v[24:27], v11 offset:8192
    ds_read_b128 v[28:31], v12 offset:9216
    ds_read_b128 v[32:35], v11 offset:10240
    ds_read_b128 v[36:39], v12 offset:11264
    s_mov_b64 exec, 1
    ds_write_b32 v2, v3 offset:100
    s_mov_b64 exec, -1
    s_waitcnt lgkmcnt(6)
    buffer_store_dwordx4 v[16:19], v5, s[16:19], s43 offen offset:0 sc1
    s_waitcnt lgkmcnt(5)
    buffer_store_dwordx4 v[20:23], v5, s[16:19], s43 offen offset:3072 sc1
    s_waitcnt lgkmcnt(4)
    buffer_store_dwordx4 v[24:27], v5, s[16:19], s43 offen offset:128 sc1
    s_waitcnt lgkmcnt(3)
    buffer_store_dwordx4 v[28:31], v5, s[16:19], s43 offen offset:3200 sc1
    s_waitcnt lgkmcnt(2)
    buffer_store_dwordx4 v[32:35], v5, s[16:19], s43 offen offset:256 sc1
    s_waitcnt lgkmcnt(1)
    buffer_store_dwordx4 v[36:39], v5, s[16:19], s43 offen offset:3328 sc1
    s_add_u32 s43, s43, s33
    s_waitcnt lgkmcnt(0)
    v_mov_b32 v3, 3
L_sp45:
    ds_read_b32 v253, v2 offset:88
    s_sub_u32 s46, s46, 1
    s_cbranch_scc1 L_sx45
    s_waitcnt lgkmcnt(0)
    v_readfirstlane_b32 s44, v253
    s_nop 1
    s_cmp_gt_u32 s44, 2
    s_cbranch_scc0 L_sp45
    s_branch L_sy45
L_sx45:
    s_mov_b32 s46, 0
    s_waitcnt lgkmcnt(0)
L_sy45:
    ds_read_b128 v[16:19], v11 offset:12288
    ds_read_b128 v[20:23], v12 offset:13312
    ds_read_b128 v[24:27], v11 offset:14336
    ds_read_b128 v[28:31], v12 offset:15360
    ds_read_b128 v[32:35], v11 offset:16384
    ds_read_b128 v[36:39], v12 offset:17408
    s_mov_b64 exec, 1
    ds_write_b32 v2, v3 offset:104
    s_mov_b64 exec, -1
    s_waitcnt lgkmcnt(6)
    buffer_store_dwordx4 v[16:19], v5, s[16:19], s43 offen offset:0 sc1
    s_waitcnt lgkmcnt(5)
    buffer_store_dwordx4 v[20:23], v5, s[16:19], s43 offen offset:3072 sc1
    s_waitcnt lgkmcnt(4)
    buffer_store_dwordx4 v[24:27], v5, s[16:19], s43 offen offset:128 sc1
    s_waitcnt lgkmcnt(3)
    buffer_store_dwordx4 v[28:31], v5, s[16:19], s43 offen offset:3200 sc1
    s_waitcnt lgkmcnt(2)
    buffer_store_dwordx4 v[32:35], v5, s[16:19], s43 offen offset:256 sc1
    s_waitcnt lgkmcnt(1)
    buffer_store_dwordx4 v[36:39], v5, s[16:19], s43 offen offset:3328 sc1
    s_add_u32 s43, s43, s33
    s_waitcnt lgkmcnt(0)
    v_mov_b32 v3, 3
L_sp46:
    ds_read_b32 v253, v2 offset:92
    s_sub_u32 s46, s46, 1
    s_cbranch_scc1 L_sx46
    s_waitcnt lgkmcnt(0)
    v_readfirstlane_b32 s44, v253
    s_nop 1
    s_cmp_gt_u32 s44, 2
    s_cbranch_scc0 L_sp46
    s_branch L_sy46
L_sx46:
    s_mov_b32 s46, 0
    s_waitcnt lgkmcnt(0)
L_sy46:
    ds_read_b128 v[16:19], v11 offset:18432
    ds_read_b128 v[20:23], v12 offset:19456
    ds_read_b128 v[24:27], v11 offset:20480
    ds_read_b128 v[28:31], v12 offset:21504
    ds_read_b128 v[32:35], v11 offset:22528
    ds_read_b128 v[36:39], v12 offset:23552
    s_mov_b64 exec, 1
    ds_write_b32 v2, v3 offset:108
    s_mov_b64 exec, -1
    s_waitcnt lgkmcnt(6)
    buffer_store_dwordx4 v[16:19], v5, s[16:19], s43 offen offset:0 sc1
    s_waitcnt lgkmcnt(5)
    buffer_store_dwordx4 v[20:23], v5, s[16:19], s43 offen offset:3072 sc1
    s_waitcnt lgkmcnt(4)
    buffer_store_dwordx4 v[24:27], v5, s[16:19], s43 offen offset:128 sc1
    s_waitcnt lgkmcnt(3)
    buffer_store_dwordx4 v[28:31], v5, s[16:19], s43 offen offset:3200 sc1
    s_waitcnt lgkmcnt(2)
    buffer_store_dwordx4 v[32:35], v5, s[16:19], s43 offen offset:256 sc1
    s_waitcnt lgkmcnt(1)
    buffer_store_dwordx4 v[36:39], v5, s[16:19], s43 offen offset:3328 sc1
    s_add_u32 s43, s43, s33
    s_waitcnt lgkmcnt(0)
    s_endpgm
G_qk:
    ds_read_b128 v[108:111], v20 offset:0
    ds_read_b128 v[112:115], v21 offset:0
    ds_read_b128 v[116:119], v20 offset:128
    ds_read_b128 v[120:123], v21 offset:128
    ds_read_b128 v[124:127], v20 offset:256
    ds_read_b128 v[128:131], v21 offset:256
    ds_read_b128 v[132:135], v22 offset:0
    ds_read_b128 v[136:139], v23 offset:0
    ds_read_b128 v[140:143], v22 offset:128
    ds_read_b128 v[144:147], v23 offset:128
    ds_read_b128 v[148:151], v22 offset:256
    ds_read_b128 v[152:155], v23 offset:256
    s_mov_b64 exec, 1
    ds_write_b32 v2, v3 offset:0
    s_mov_b64 exec, -1
    s_waitcnt lgkmcnt(12)
    v_mfma_f32_16x16x32_bf16 v[156:159], v[108:111], v[84:87], 0
    s_waitcnt lgkmcnt(11)
    v_mfma_f32_16x16x32_bf16 v[156:159], v[112:115], v[88:91], v[156:159]
    s_waitcnt lgkmcnt(10)
    v_mfma_f32_16x16x32_bf16 v[156:159], v[116:119], v[92:95], v[156:159]
    s_waitcnt lgkmcnt(9)
    v_mfma_f32_16x16x32_bf16 v[156:159], v[120:123], v[96:99], v[156:159]
    s_waitcnt lgkmcnt(8)
    v_mfma_f32_16x16x32_bf16 v[156:159], v[124:127], v[100:103], v[156:159]
    s_waitcnt lgkmcnt(7)
    v_mfma_f32_16x16x32_bf16 v[156:159], v[128:131], v[104:107], v[156:159]
    s_waitcnt lgkmcnt(6)
    v_mfma_f32_16x16x32_bf16 v[160:163], v[132:135], v[84:87], 0
    s_waitcnt lgkmcnt(5)
    v_mfma_f32_16x16x32_bf16 v[160:163], v[136:139], v[88:91], v[160:163]
    s_waitcnt lgkmcnt(4)
    v_mfma_f32_16x16x32_bf16 v[160:163], v[140:143], v[92:95], v[160:163]
    s_waitcnt lgkmcnt(3)
    v_mfma_f32_16x16x32_bf16 v[160:163], v[144:147], v[96:99], v[160:163]
    s_waitcnt lgkmcnt(2)
    v_mfma_f32_16x16x32_bf16 v[160:163], v[148:151], v[100:103], v[160:163]
    s_waitcnt lgkmcnt(1)
    v_mfma_f32_16x16x32_bf16 v[160:163], v[152:155], v[104:107], v[160:163]
    v_max3_f32 v52, v50, v156, v157
    v_max3_f32 v52, v52, v158, v159
    s_nop 5
    v_max3_f32 v52, v52, v160, v161
    v_max3_f32 v52, v52, v162, v163
    v_mov_b32 v53, v52
    s_nop 1
    v_permlane32_swap_b32 v52, v53
    v_max_f32 v52, v52, v53
    v_mov_b32 v53, v52
    s_nop 1
    v_permlane16_swap_b32 v52, v53
    v_max_f32 v52, v52, v53
    v_sub_f32 v54, v50, v52
    v_mul_f32 v53, s42, v52
    v_mul_f32 v54, s42, v54
    v_mov_b32 v50, v52
    v_exp_f32 v54, v54
    v_fma_f32 v156, v156, s42, -v53
    v_fma_f32 v157, v157, s42, -v53
    v_fma_f32 v158, v158, s42, -v53
    v_fma_f32 v159, v159, s42, -v53
    v_fma_f32 v160, v160, s42, -v53
    v_fma_f32 v161, v161, s42, -v53
    v_fma_f32 v162, v162, s42, -v53
    v_fma_f32 v163, v163, s42, -v53
    v_exp_f32 v156, v156
    v_exp_f32 v157, v157
    v_exp_f32 v158, v158
    v_exp_f32 v159, v159
    v_exp_f32 v160, v160
    v_exp_f32 v161, v161
    v_exp_f32 v162, v162
    v_exp_f32 v163, v163
    v_mul_f32 v208, v54, v208
    v_mul_f32 v209, v54, v209
    v_mul_f32 v210, v54, v210
    v_mul_f32 v211, v54, v211
    v_mul_f32 v212, v54, v212
    v_mul_f32 v213, v54, v213
    v_mul_f32 v214, v54, v214
    v_mul_f32 v215, v54, v215
    v_cvt_pk_bf16_f32 v164, v156, v157
    v_cvt_pk_bf16_f32 v165, v158, v159
    v_cvt_pk_bf16_f32 v166, v160, v161
    v_cvt_pk_bf16_f32 v167, v162, v163
    v_cndmask_b32 v168, 0, v164, s[50:51]
    v_cndmask_b32 v169, 0, v165, s[50:51]
    v_cndmask_b32 v170, 0, v166, s[50:51]
    v_cndmask_b32 v171, 0, v167, s[50:51]
    v_cndmask_b32 v172, 0, v164, s[52:53]
    v_cndmask_b32 v173, 0, v165, s[52:53]
    v_cndmask_b32 v174, 0, v166, s[52:53]
    v_cndmask_b32 v175, 0, v167, s[52:53]
    v_cndmask_b32 v176, 0, v164, s[54:55]
    v_cndmask_b32 v177, 0, v165, s[54:55]
    v_cndmask_b32 v178, 0, v166, s[54:55]
    v_cndmask_b32 v179, 0, v167, s[54:55]
    v_cndmask_b32 v180, 0, v164, s[56:57]
    v_cndmask_b32 v181, 0, v165, s[56:57]
    v_cndmask_b32 v182, 0, v166, s[56:57]
    v_cndmask_b32 v183, 0, v167, s[56:57]
    v_cndmask_b32 v184, 0, v164, s[58:59]
    v_cndmask_b32 v185, 0, v165, s[58:59]
    v_cndmask_b32 v186, 0, v166, s[58:59]
    v_cndmask_b32 v187, 0, v167, s[58:59]
    v_cndmask_b32 v188, 0, v164, s[60:61]
    v_cndmask_b32 v189, 0, v165, s[60:61]
    v_cndmask_b32 v190, 0, v166, s[60:61]
    v_cndmask_b32 v191, 0, v167, s[60:61]
    v_cndmask_b32 v192, 0, v164, s[62:63]
    v_cndmask_b32 v193, 0, v165, s[62:63]
    v_cndmask_b32 v194, 0, v166, s[62:63]
    v_cndmask_b32 v195, 0, v167, s[62:63]
    v_cndmask_b32 v196, 0, v164, s[64:65]
    v_cndmask_b32 v197, 0, v165, s[64:65]
    v_cndmask_b32 v198, 0, v166, s[64:65]
    v_cndmask_b32 v199, 0, v167, s[64:65]
    s_waitcnt lgkmcnt(0)
    s_setpc_b64 s[40:41]
G_pv:
    ds_read_b64_tr_b16 v[220:221], v30 offset:0
    ds_read_b64_tr_b16 v[222:223], v34 offset:0
    ds_read_b64_tr_b16 v[224:225], v31 offset:0
    ds_read_b64_tr_b16 v[226:227], v35 offset:0
    ds_read_b64_tr_b16 v[228:229], v32 offset:0
    ds_read_b64_tr_b16 v[230:231], v36 offset:0
    ds_read_b64_tr_b16 v[232:233], v33 offset:0
    ds_read_b64_tr_b16 v[234:235], v37 offset:0
    ds_read_b64_tr_b16 v[236:237], v30 offset:128
    ds_read_b64_tr_b16 v[238:239], v34 offset:128
    ds_read_b64_tr_b16 v[240:241], v31 offset:128
    ds_read_b64_tr_b16 v[242:243], v35 offset:128
    ds_read_b64_tr_b16 v[244:245], v32 offset:128
    ds_read_b64_tr_b16 v[246:247], v36 offset:128
    v_mfma_f32_16x16x32_bf16 v[212:215], v[56:59], v[184:187], v[212:215]
    s_waitcnt lgkmcnt(12)
    v_mfma_f32_16x16x32_bf16 v[208:211], v[220:223], v[168:171], v[208:211]
    ds_read_b64_tr_b16 v[248:249], v33 offset:128
    ds_read_b64_tr_b16 v[250:251], v37 offset:128
    s_waitcnt lgkmcnt(12)
    v_mfma_f32_16x16x32_bf16 v[208:211], v[224:227], v[172:175], v[208:211]
    ds_read_b64_tr_b16 v[220:221], v30 offset:256
    ds_read_b64_tr_b16 v[222:223], v34 offset:256
    s_waitcnt lgkmcnt(12)
    v_mfma_f32_16x16x32_bf16 v[208:211], v[228:231], v[176:179], v[208:211]
    ds_read_b64_tr_b16 v[224:225], v31 offset:256
    ds_read_b64_tr_b16 v[226:227], v35 offset:256
    s_waitcnt lgkmcnt(12)
    v_mfma_f32_16x16x32_bf16 v[208:211], v[232:235], v[180:183], v[208:211]
    ds_read_b64_tr_b16 v[228:229], v32 offset:256
    ds_read_b64_tr_b16 v[230:231], v36 offset:256
    s_waitcnt lgkmcnt(12)
    v_mfma_f32_16x16x32_bf16 v[208:211], v[236:239], v[184:187], v[208:211]
    ds_read_b64_tr_b16 v[232:233], v33 offset:256
    ds_read_b64_tr_b16 v[234:235], v37 offset:256
    s_mov_b64 exec, 1
    ds_write_b32 v2, v3 offset:32
    s_mov_b64 exec, -1
    s_waitcnt lgkmcnt(13)
    v_mfma_f32_16x16x32_bf16 v[208:211], v[240:243], v[188:191], v[208:211]
    s_waitcnt lgkmcnt(11)
    v_mfma_f32_16x16x32_bf16 v[208:211], v[244:247], v[192:195], v[208:211]
    s_waitcnt lgkmcnt(9)
    v_mfma_f32_16x16x32_bf16 v[208:211], v[248:251], v[196:199], v[208:211]
    s_waitcnt lgkmcnt(7)
    v_mfma_f32_16x16x32_bf16 v[212:215], v[220:223], v[168:171], v[212:215]
    s_waitcnt lgkmcnt(5)
    v_mfma_f32_16x16x32_bf16 v[212:215], v[224:227], v[172:175], v[212:215]
    s_waitcnt lgkmcnt(3)
    v_mfma_f32_16x16x32_bf16 v[212:215], v[228:231], v[176:179], v[212:215]
    s_waitcnt lgkmcnt(1)
    v_mfma_f32_16x16x32_bf16 v[212:215], v[232:235], v[180:183], v[212:215]
    s_waitcnt lgkmcnt(0)
    s_nop 5
    s_setpc_b64 s[40:41]
L_gmain:
    s_mov_b32 s26, 256
    s_mov_b32 s27, 0x20000
    s_mov_b32 s22, 524288
    s_mov_b32 s23, 0x20000
    s_lshl_b32 s92, s29, 14
    s_lshl_b32 s43, s30, 11
    s_add_u32 s43, s43, s92
    s_mov_b32 s99, 0
    v_and_b32 v52, 1, v0
    v_lshlrev_b32 v52, 10, v52
    v_and_b32 v53, 0x30, v0
    v_add_u32 v52, v53, v52
    v_bfe_u32 v53, v0, 1, 3
    v_lshl_add_u32 v5, v53, 6, v52
    v_bfrev_b32 v54, 1
    s_mov_b32 s94, 0x03ff03ff
    s_mov_b32 s95, 0x03ff03ff
    v_cndmask_b32 v6, v54, v5, s[94:95]
    v_lshrrev_b32 v52, 5, v0
    v_and_b32 v53, 31, v0
    v_lshlrev_b32 v8, 10, v52
    v_lshl_add_u32 v7, v53, 5, v8
    v_mul_u32_u24 v52, 384, v52
    v_lshl_add_u32 v9, v53, 4, v52
    s_lshl_b32 s36, s29, 2
    v_mov_b32 v10, s36
    v_mov_b32 v11, 1
    s_mov_b32 s50, 0x30003
    s_mov_b32 s51, 0x30003
    s_mov_b32 s52, 0xc000c
    s_mov_b32 s53, 0xc000c
    s_mov_b32 s54, 0x300030
    s_mov_b32 s55, 0x300030
    s_mov_b32 s56, 0xc000c0
    s_mov_b32 s57, 0xc000c0
    s_mov_b32 s58, 0x3000300
    s_mov_b32 s59, 0x3000300
    s_mov_b32 s60, 0xc000c00
    s_mov_b32 s61, 0xc000c00
    s_mov_b32 s62, 0x30003000
    s_mov_b32 s63, 0x30003000
    s_mov_b32 s64, 0xc000c000
    s_mov_b32 s65, 0xc000c000
    v_mov_b32 v208, 0
    v_mov_b32 v209, 0
    v_mov_b32 v210, 0
    v_mov_b32 v211, 0
    v_mov_b32 v212, 0
    v_mov_b32 v213, 0
    v_mov_b32 v214, 0
    v_mov_b32 v215, 0
    v_mov_b32 v50, 0xff800000
    s_waitcnt vmcnt(0)
    v_add_u32 v20, 12288, v13
    v_add_u32 v21, 12288, v14
    v_add_u32 v30, 12288, v15
    v_add_u32 v31, 12288, v16
    v_add_u32 v32, 12288, v17
    v_add_u32 v33, 12288, v18
    v_add_u32 v22, 18432, v13
    v_add_u32 v23, 18432, v14
    v_add_u32 v34, 18432, v15
    v_add_u32 v35, 18432, v16
    v_add_u32 v36, 18432, v17
    v_add_u32 v37, 18432, v18
    v_mov_b32 v3, 1
    s_movk_i32 s45, 5
    s_call_b64 s[40:41], F_poll
    s_call_b64 s[40:41], G_qk
    s_movk_i32 s45, 12
    s_call_b64 s[40:41], F_poll
    s_call_b64 s[40:41], G_pv
    v_add_u32 v20, 24576, v13
    v_add_u32 v21, 24576, v14
    v_add_u32 v30, 24576, v15
    v_add_u32 v31, 24576, v16
    v_add_u32 v32, 24576, v17
    v_add_u32 v33, 24576, v18
    v_add_u32 v22, 30720, v13
    v_add_u32 v23, 30720, v14
    v_add_u32 v34, 30720, v15
    v_add_u32 v35, 30720, v16
    v_add_u32 v36, 30720, v17
    v_add_u32 v37, 30720, v18
    v_mov_b32 v3, 2
    s_movk_i32 s45, 8
    s_call_b64 s[40:41], F_poll
    s_call_b64 s[40:41], G_qk
    s_movk_i32 s45, 16
    s_call_b64 s[40:41], F_poll
    s_call_b64 s[40:41], G_pv
    v_add_u32 v20, 36864, v13
    v_add_u32 v21, 36864, v14
    v_add_u32 v30, 36864, v15
    v_add_u32 v31, 36864, v16
    v_add_u32 v32, 36864, v17
    v_add_u32 v33, 36864, v18
    v_add_u32 v22, 43008, v13
    v_add_u32 v23, 43008, v14
    v_add_u32 v34, 43008, v15
    v_add_u32 v35, 43008, v16
    v_add_u32 v36, 43008, v17
    v_add_u32 v37, 43008, v18
    v_mov_b32 v3, 3
    s_movk_i32 s45, 18
    s_call_b64 s[40:41], F_poll
    s_call_b64 s[40:41], G_qk
    s_movk_i32 s45, 22
    s_call_b64 s[40:41], F_poll
    s_call_b64 s[40:41], G_pv
    v_add_u32 v20, 49152, v13
    v_add_u32 v21, 49152, v14
    v_add_u32 v30, 49152, v15
    v_add_u32 v31, 49152, v16
    v_add_u32 v32, 49152, v17
    v_add_u32 v33, 49152, v18
    v_add_u32 v22, 0, v13
    v_add_u32 v23, 0, v14
    v_add_u32 v34, 0, v15
    v_add_u32 v35, 0, v16
    v_add_u32 v36, 0, v17
    v_add_u32 v37, 0, v18
    v_mov_b32 v3, 4
    s_movk_i32 s45, 24
    s_call_b64 s[40:41], F_poll
    s_call_b64 s[40:41], G_qk
    s_movk_i32 s45, 28
    s_call_b64 s[40:41], F_poll
    s_call_b64 s[40:41], G_pv
    v_add_u32 v20, 6144, v13
    v_add_u32 v21, 6144, v14
    v_add_u32 v30, 6144, v15
    v_add_u32 v31, 6144, v16
    v_add_u32 v32, 6144, v17
    v_add_u32 v33, 6144, v18
    v_add_u32 v22, 12288, v13
    v_add_u32 v23, 12288, v14
    v_add_u32 v34, 12288, v15
    v_add_u32 v35, 12288, v16
    v_add_u32 v36, 12288, v17
    v_add_u32 v37, 12288, v18
    v_mov_b32 v3, 5
    s_movk_i32 s45, 30
    s_call_b64 s[40:41], F_poll
    s_call_b64 s[40:41], G_qk
    s_movk_i32 s45, 34
    s_call_b64 s[40:41], F_poll
    s_call_b64 s[40:41], G_pv
    v_add_u32 v20, 18432, v13
    v_add_u32 v21, 18432, v14
    v_add_u32 v30, 18432, v15
    v_add_u32 v31, 18432, v16
    v_add_u32 v32, 18432, v17
    v_add_u32 v33, 18432, v18
    v_add_u32 v22, 24576, v13
    v_add_u32 v23, 24576, v14
    v_add_u32 v34, 24576, v15
    v_add_u32 v35, 24576, v16
    v_add_u32 v36, 24576, v17
    v_add_u32 v37, 24576, v18
    v_mov_b32 v3, 6
    s_movk_i32 s45, 36
    s_call_b64 s[40:41], F_poll
    s_call_b64 s[40:41], G_qk
    s_movk_i32 s45, 38
    s_call_b64 s[40:41], F_poll
    s_call_b64 s[40:41], G_pv
    v_add_u32 v20, 30720, v13
    v_add_u32 v21, 30720, v14
    v_add_u32 v30, 30720, v15
    v_add_u32 v31, 30720, v16
    v_add_u32 v32, 30720, v17
    v_add_u32 v33, 30720, v18
    v_add_u32 v22, 36864, v13
    v_add_u32 v23, 36864, v14
    v_add_u32 v34, 36864, v15
    v_add_u32 v35, 36864, v16
    v_add_u32 v36, 36864, v17
    v_add_u32 v37, 36864, v18
    v_mov_b32 v3, 7
    s_movk_i32 s45, 41
    s_call_b64 s[40:41], F_poll
    s_call_b64 s[40:41], G_qk
    s_movk_i32 s45, 43
    s_call_b64 s[40:41], F_poll
    s_call_b64 s[40:41], G_pv
    v_add_u32 v20, 43008, v13
    v_add_u32 v21, 43008, v14
    v_add_u32 v30, 43008, v15
    v_add_u32 v31, 43008, v16
    v_add_u32 v32, 43008, v17
    v_add_u32 v33, 43008, v18
    v_add_u32 v22, 49152, v13
    v_add_u32 v23, 49152, v14
    v_add_u32 v34, 49152, v15
    v_add_u32 v35, 49152, v16
    v_add_u32 v36, 49152, v17
    v_add_u32 v37, 49152, v18
    v_mov_b32 v3, 8
    s_setprio 3
    s_movk_i32 s45, 46
    s_call_b64 s[40:41], F_poll
    s_call_b64 s[40:41], G_qk
    s_movk_i32 s45, 48
    s_call_b64 s[40:41], F_poll
    s_call_b64 s[40:41], G_pv
L_gtail:
    buffer_store_dwordx4 v[208:211], v5, s[20:23], s43 offen sc1
    v_cndmask_b32 v213, v213, v50, s[58:59]
    buffer_store_dwordx4 v[212:215], v6, s[20:23], s43 offen offset:512 sc1
    s_mov_b64 exec, 1
    s_waitcnt vmcnt(0)
    buffer_atomic_add v11, v10, s[24:27], 0 offen sc0
    s_mov_b32 exec_lo, 0x00ffffff
    s_mov_b32 exec_hi, 0x00ffffff
    s_waitcnt vmcnt(0)
    v_readfirstlane_b32 s36, v11
    s_nop 1
    s_cmp_eq_u32 s36, 7
    s_cbranch_scc0 L_end2
    s_add_u32 s35, s92, 4096
    s_add_u32 s36, s92, 8192
    s_add_u32 s37, s92, 12288
    buffer_load_dwordx2 v[172:173], v8, s[20:23], s92 offen offset:768 sc1
    buffer_load_dwordx2 v[174:175], v8, s[20:23], s92 offen offset:2816 sc1
    buffer_load_dwordx2 v[176:177], v8, s[20:23], s35 offen offset:768 sc1
    buffer_load_dwordx2 v[178:179], v8, s[20:23], s35 offen offset:2816 sc1
    buffer_load_dwordx2 v[180:181], v8, s[20:23], s36 offen offset:768 sc1
    buffer_load_dwordx2 v[182:183], v8, s[20:23], s36 offen offset:2816 sc1
    buffer_load_dwordx2 v[184:185], v8, s[20:23], s37 offen offset:768 sc1
    buffer_load_dwordx2 v[186:187], v8, s[20:23], s37 offen offset:2816 sc1
    buffer_load_dwordx4 v[108:111], v7, s[20:23], s92 offen offset:0 sc1
    buffer_load_dwordx4 v[112:115], v7, s[20:23], s92 offen offset:16 sc1
    buffer_load_dwordx4 v[116:119], v7, s[20:23], s92 offen offset:2048 sc1
    buffer_load_dwordx4 v[120:123], v7, s[20:23], s92 offen offset:2064 sc1
    buffer_load_dwordx4 v[124:127], v7, s[20:23], s35 offen offset:0 sc1
    buffer_load_dwordx4 v[128:131], v7, s[20:23], s35 offen offset:16 sc1
    buffer_load_dwordx4 v[132:135], v7, s[20:23], s35 offen offset:2048 sc1
    buffer_load_dwordx4 v[136:139], v7, s[20:23], s35 offen offset:2064 sc1
    buffer_load_dwordx4 v[140:143], v7, s[20:23], s36 offen offset:0 sc1
    buffer_load_dwordx4 v[144:147], v7, s[20:23], s36 offen offset:16 sc1
    buffer_load_dwordx4 v[148:151], v7, s[20:23], s36 offen offset:2048 sc1
    buffer_load_dwordx4 v[152:155], v7, s[20:23], s36 offen offset:2064 sc1
    buffer_load_dwordx4 v[156:159], v7, s[20:23], s37 offen offset:0 sc1
    buffer_load_dwordx4 v[160:163], v7, s[20:23], s37 offen offset:16 sc1
    buffer_load_dwordx4 v[164:167], v7, s[20:23], s37 offen offset:2048 sc1
    buffer_load_dwordx4 v[168:171], v7, s[20:23], s37 offen offset:2064 sc1
    s_call_b64 s[40:41], G_comb
    buffer_store_dwordx4 v[220:223], v9, s[16:19], s34 offen sc1
L_end2:
    s_endpgm
G_comb:
    s_waitcnt vmcnt(16)
    v_max3_f32 v53, v173, v175, v177
    v_max3_f32 v52, v179, v181, v183
    v_max3_f32 v53, v53, v185, v187
    v_max_f32 v53, v53, v52
    v_mul_f32 v53, s42, v53
    v_fma_f32 v173, v173, s42, -v53
    v_fma_f32 v175, v175, s42, -v53
    v_fma_f32 v177, v177, s42, -v53
    v_fma_f32 v179, v179, s42, -v53
    v_fma_f32 v181, v181, s42, -v53
    v_fma_f32 v183, v183, s42, -v53
    v_fma_f32 v185, v185, s42, -v53
    v_fma_f32 v187, v187, s42, -v53
    v_exp_f32 v173, v173
    v_exp_f32 v175, v175
    v_exp_f32 v177, v177
    v_exp_f32 v179, v179
    v_exp_f32 v181, v181
    v_exp_f32 v183, v183
    v_exp_f32 v185, v185
    v_exp_f32 v187, v187
    v_mul_f32 v54, v172, v173
    v_fmac_f32 v54, v174, v175
    v_fmac_f32 v54, v176, v177
    v_fmac_f32 v54, v178, v179
    v_fmac_f32 v54, v180, v181
    v_fmac_f32 v54, v182, v183
    v_fmac_f32 v54, v184, v185
    v_fmac_f32 v54, v186, v187
    v_rcp_f32 v54, v54
    s_nop 0
    v_mul_f32 v172, v54, v173
    v_mul_f32 v174, v54, v175
    v_mul_f32 v176, v54, v177
    v_mul_f32 v178, v54, v179
    v_mul_f32 v180, v54, v181
    v_mul_f32 v182, v54, v183
    v_mul_f32 v184, v54, v185
    v_mul_f32 v186, v54, v187
    s_waitcnt vmcnt(14)
    v_pk_mul_f32 v[108:109], v[108:109], v[172:173] op_sel_hi:[1,0]
    v_pk_mul_f32 v[110:111], v[110:111], v[172:173] op_sel_hi:[1,0]
    v_pk_mul_f32 v[112:113], v[112:113], v[172:173] op_sel_hi:[1,0]
    v_pk_mul_f32 v[114:115], v[114:115], v[172:173] op_sel_hi:[1,0]
    s_waitcnt vmcnt(12)
    v_pk_fma_f32 v[108:109], v[116:117], v[174:175], v[108:109] op_sel_hi:[1,0,1]
    v_pk_fma_f32 v[110:111], v[118:119], v[174:175], v[110:111] op_sel_hi:[1,0,1]
    v_pk_fma_f32 v[112:113], v[120:121], v[174:175], v[112:113] op_sel_hi:[1,0,1]
    v_pk_fma_f32 v[114:115], v[122:123], v[174:175], v[114:115] op_sel_hi:[1,0,1]
    s_waitcnt vmcnt(10)
    v_pk_fma_f32 v[108:109], v[124:125], v[176:177], v[108:109] op_sel_hi:[1,0,1]
    v_pk_fma_f32 v[110:111], v[126:127], v[176:177], v[110:111] op_sel_hi:[1,0,1]
    v_pk_fma_f32 v[112:113], v[128:129], v[176:177], v[112:113] op_sel_hi:[1,0,1]
    v_pk_fma_f32 v[114:115], v[130:131], v[176:177], v[114:115] op_sel_hi:[1,0,1]
    s_waitcnt vmcnt(8)
    v_pk_fma_f32 v[108:109], v[132:133], v[178:179], v[108:109] op_sel_hi:[1,0,1]
    v_pk_fma_f32 v[110:111], v[134:135], v[178:179], v[110:111] op_sel_hi:[1,0,1]
    v_pk_fma_f32 v[112:113], v[136:137], v[178:179], v[112:113] op_sel_hi:[1,0,1]
    v_pk_fma_f32 v[114:115], v[138:139], v[178:179], v[114:115] op_sel_hi:[1,0,1]
    s_waitcnt vmcnt(6)
    v_pk_fma_f32 v[108:109], v[140:141], v[180:181], v[108:109] op_sel_hi:[1,0,1]
    v_pk_fma_f32 v[110:111], v[142:143], v[180:181], v[110:111] op_sel_hi:[1,0,1]
    v_pk_fma_f32 v[112:113], v[144:145], v[180:181], v[112:113] op_sel_hi:[1,0,1]
    v_pk_fma_f32 v[114:115], v[146:147], v[180:181], v[114:115] op_sel_hi:[1,0,1]
    s_waitcnt vmcnt(4)
    v_pk_fma_f32 v[108:109], v[148:149], v[182:183], v[108:109] op_sel_hi:[1,0,1]
    v_pk_fma_f32 v[110:111], v[150:151], v[182:183], v[110:111] op_sel_hi:[1,0,1]
    v_pk_fma_f32 v[112:113], v[152:153], v[182:183], v[112:113] op_sel_hi:[1,0,1]
    v_pk_fma_f32 v[114:115], v[154:155], v[182:183], v[114:115] op_sel_hi:[1,0,1]
    s_waitcnt vmcnt(2)
    v_pk_fma_f32 v[108:109], v[156:157], v[184:185], v[108:109] op_sel_hi:[1,0,1]
    v_pk_fma_f32 v[110:111], v[158:159], v[184:185], v[110:111] op_sel_hi:[1,0,1]
    v_pk_fma_f32 v[112:113], v[160:161], v[184:185], v[112:113] op_sel_hi:[1,0,1]
    v_pk_fma_f32 v[114:115], v[162:163], v[184:185], v[114:115] op_sel_hi:[1,0,1]
    s_waitcnt vmcnt(0)
    v_pk_fma_f32 v[108:109], v[164:165], v[186:187], v[108:109] op_sel_hi:[1,0,1]
    v_pk_fma_f32 v[110:111], v[166:167], v[186:187], v[110:111] op_sel_hi:[1,0,1]
    v_pk_fma_f32 v[112:113], v[168:169], v[186:187], v[112:113] op_sel_hi:[1,0,1]
    v_pk_fma_f32 v[114:115], v[170:171], v[186:187], v[114:115] op_sel_hi:[1,0,1]
    v_cvt_pk_bf16_f32 v220, v108, v109
    v_cvt_pk_bf16_f32 v221, v110, v111
    v_cvt_pk_bf16_f32 v222, v112, v113
    v_cvt_pk_bf16_f32 v223, v114, v115
    s_setpc_b64 s[40:41]
.fill 256, 4, 0xbf800000
.section .rodata,"a"
.p2align 6
.amdhsa_kernel standalone__global_local_windowed_global_tokens__prompt_kernel
  .amdhsa_next_free_vgpr 256
  .amdhsa_next_free_sgpr 102
  .amdhsa_accum_offset 256
  .amdhsa_group_segment_fixed_size 0
  .amdhsa_kernarg_size 64
  .amdhsa_user_sgpr_count 2
  .amdhsa_user_sgpr_kernarg_segment_ptr 1
  .amdhsa_system_sgpr_workgroup_id_x 1
  .amdhsa_float_denorm_mode_32 3
.end_amdhsa_kernel
```
